```python
import torch

def _softmax(x, axis=-1):
    return torch.softmax(x, dim=axis)
def _gelu(x):
    return torch.nn.functional.gelu(x, approximate="tanh")
def _silu(x):
    return torch.nn.functional.silu(x)
def _sigmoid(x):
    return torch.sigmoid(x)
def _layernorm(x, axis=-1, eps=1e-5):
    m = x.mean(dim=axis, keepdim=True)
    v = x.var(dim=axis, keepdim=True, unbiased=False)
    return (x - m) / torch.sqrt(v + eps)
def _scatter_add(tgt, idx, src, axis=0):
    return tgt.clone().index_add_(axis, idx, src)
def _segment_sum(src, seg, n):
    out = torch.zeros((n,) + src.shape[1:], dtype=src.dtype)
    return out.index_add_(0, seg, src)
def _pad(x, pw):
    flat = tuple(v for pair in reversed(pw) for v in pair)
    return torch.nn.functional.pad(x, flat)

kernel_name = 'sequential_preLN__sliding_local_dilated__glu_gated_bilinear__prompt'

def setup_inputs():

    _w = (lambda a: (lambda t: t.to(torch.bfloat16) if t.is_floating_point() else t)(torch.as_tensor(a)))
    def _A_setup():
        B, S, D = 1, 2048, 512
        return {
            "x": _w((lambda *s: torch.randn(*s, dtype=torch.bfloat16) * 0.05)(B, S, D)),
            "wqkv": _w((lambda *s: torch.randn(*s, dtype=torch.bfloat16) * 0.05)(D, 3 * D)),
            "wo": _w((lambda *s: torch.randn(*s, dtype=torch.bfloat16) * 0.05)(D, D)),
        }
    _A_in = _A_setup()

    def _B_setup():
        B, S, D, F = 1, 2048, 512, 1792
        return {
            "x": _w((lambda *s: torch.randn(*s, dtype=torch.bfloat16) * 0.05)(B, S, D)),
            "w_gate": _w((lambda *s: torch.randn(*s, dtype=torch.bfloat16) * 0.8)(D, F) * (D ** -0.5)),
            "w_up": _w((lambda *s: torch.randn(*s, dtype=torch.bfloat16) * 0.8)(D, F) * (D ** -0.5)),
            "w_down": _w((lambda *s: torch.randn(*s, dtype=torch.bfloat16) * 0.8)(F, D) * (F ** -0.5)),
        }
    _B_in = _B_setup()

    return {
        "A_x": _A_in["x"],
        "A_wqkv": _A_in["wqkv"],
        "A_wo": _A_in["wo"],
        "B_x": _B_in["x"],
        "B_w_gate": _B_in["w_gate"],
        "B_w_up": _B_in["w_up"],
        "B_w_down": _B_in["w_down"],
    }

def reference(A_x, A_wqkv, A_wo, B_x, B_w_gate, B_w_up, B_w_down):
    def _A_ref(x, wqkv, wo):
        B, S, D = x.shape
        H = 32; Dh = D // H
        W, dil = 8, 2
        qkv = (lambda x, *d: x.permute(*d))((x @ wqkv).reshape(B, S, 3, H, Dh), 2, 0, 3, 1, 4)
        q, k, v = qkv[0], qkv[1], qkv[2]
        scale = Dh ** -0.5
        pos = torch.arange(S)
        off = torch.arange(W) * dil
        idx = pos[:, None] - off[None, :]
        mask = idx >= 0
        idx_c = torch.where(mask, idx, 0).reshape(-1)
        kg = k[:, :, idx_c, :].reshape(B, H, S, W, Dh)
        vg = v[:, :, idx_c, :].reshape(B, H, S, W, Dh)
        logits = torch.einsum("bhsd,bhswd->bhsw", q, kg) * scale
        logits = torch.where(mask[None, None, :, :], logits, -1e9)
        attn = _softmax(logits, axis=-1)
        o = torch.einsum("bhsw,bhswd->bhsd", attn, vg)
        return (lambda x, *d: x.permute(*d))(o, 0, 2, 1, 3).reshape(B, S, D) @ wo

    def _B_ref(x, w_gate, w_up, w_down):
        g = torch.einsum("bsd,df->bsf", x, w_gate)
        u = torch.einsum("bsd,df->bsf", x, w_up)
        h = g * u
        return torch.einsum("bsf,fd->bsd", h, w_down)

    x = A_x
    h = x + _A_ref(_layernorm(x, axis=-1), A_wqkv, A_wo)
    h2 = h + _B_ref(_layernorm(h, axis=-1), B_w_gate, B_w_up, B_w_down)
    return h2
```

```asm
; @launch grid=(256,1,1) block=(256,1,1) lds=163840
.amdgcn_target "amdgcn-amd-amdhsa--gfx950"
.text
.p2align 12
.fill 832, 4, 0xbf800000
.globl sequential_preLN__sliding_local_dilated__glu_gated_bilinear__prompt_kernel
.p2align 8
.type sequential_preLN__sliding_local_dilated__glu_gated_bilinear__prompt_kernel,@function
sequential_preLN__sliding_local_dilated__glu_gated_bilinear__prompt_kernel:
    s_cmp_ge_u32 s2, 256
    s_cbranch_scc1 L_exit
    s_load_dwordx2 s[24:25], s[0:1], 0
    s_load_dwordx2 s[28:29], s[0:1], 8
    s_load_dwordx2 s[48:49], s[0:1], 72
    s_load_dwordx2 s[32:33], s[0:1], 16
    s_load_dwordx2 s[60:61], s[0:1], 64
    s_load_dwordx2 s[52:53], s[0:1], 72
    s_load_dwordx2 s[56:57], s[0:1], 72
    s_load_dwordx2 s[40:41], s[0:1], 48
    s_load_dwordx2 s[44:45], s[0:1], 56
    v_lshrrev_b32 v1, 6, v0
    v_and_b32 v0, 63, v0
    v_readfirstlane_b32 s68, v1
    v_lshlrev_b32 v1, 4, v0
    s_getpc_b64 s[16:17]
    s_lshr_b32 s18, s2, 3
    s_lshl_b32 s18, s18, 2
    s_add_u32 s18, s18, s68
    s_mul_i32 s18, s18, 384
    v_lshl_add_u32 v10, v0, 7, s18
    v_min_u32 v10, L_code_end - L_code_pf, v10
    s_mov_b64 exec, 7
L_code_pf:
    global_load_dword v231, v10, s[16:17]
    s_mov_b64 exec, -1
    s_cmp_ge_u32 s68, 2
    s_cselect_b32 s77, 40, 32
    s_load_dwordx2 s[36:37], s[0:1], s77
    s_mov_b32 s26, 2097152
    s_mov_b32 s27, 0x20000
    s_getreg_b32 s73, hwreg(HW_REG_XCC_ID)
    s_and_b32 s73, s73, 7
    s_and_b32 s76, s2, 7
    s_lshr_b32 s77, s2, 3
    s_lshr_b32 s69, s77, 4
    s_lshl_b32 s76, s76, 1
    s_add_u32 s69, s69, s76
    s_and_b32 s70, s77, 15
    s_lshr_b32 s76, s70, 3
    s_lshl_b32 s71, s69, 1
    s_add_u32 s71, s71, s76
    s_and_b32 s72, s70, 7
    s_mov_b32 s94, s73
    s_and_b32 s19, s94, 7
    s_lshl_b32 s76, s19, 7
    v_add_u32 v76, s76, v1
    v_and_b32 v76, 1023, v76
    s_mul_i32 s79, s72, 5
    s_lshr_b32 s79, s79, 3
    s_lshl_b32 s75, s79, 2
    s_mul_i32 s76, s68, 20
    s_lshl_b32 s97, s71, 6
    s_add_u32 s97, s97, s76
    s_sub_u32 s97, s97, 16
    s_mul_i32 s85, s68, 21120
    s_add_u32 s85, s85, 75776
    s_waitcnt lgkmcnt(0)
    s_mul_i32 s98, s75, 1056
    s_add_u32 s98, s98, s85
    s_add_u32 s76, s75, s97
    s_max_i32 s76, s76, 0
    s_mov_b32 m0, s98
    s_lshl_b32 s76, s76, 10
    buffer_load_dwordx4 v76, s[24:27], s76 offen offset:0 nt lds
    s_add_u32 m0, s98, 32
    s_nop 0
    buffer_load_dwordx4 v76, s[24:27], s76 offen offset:1024 nt lds
    s_add_u32 m0, s98, 64
    s_nop 0
    buffer_load_dwordx4 v76, s[24:27], s76 offen offset:2048 nt lds
    s_add_u32 m0, s98, 96
    s_nop 0
    buffer_load_dwordx4 v76, s[24:27], s76 offen offset:3072 nt lds
    s_add_u32 s75, s75, 4
    s_cmp_ge_u32 s75, 20
    s_cselect_b32 s75, 0, s75
    s_mul_i32 s99, s75, 1056
    s_add_u32 s99, s99, s85
    s_add_u32 s76, s75, s97
    s_max_i32 s76, s76, 0
    s_mov_b32 m0, s99
    s_lshl_b32 s76, s76, 10
    buffer_load_dwordx4 v76, s[24:27], s76 offen offset:0 nt lds
    s_add_u32 m0, s99, 32
    s_nop 0
    buffer_load_dwordx4 v76, s[24:27], s76 offen offset:1024 nt lds
    s_add_u32 m0, s99, 64
    s_nop 0
    buffer_load_dwordx4 v76, s[24:27], s76 offen offset:2048 nt lds
    s_add_u32 m0, s99, 96
    s_nop 0
    buffer_load_dwordx4 v76, s[24:27], s76 offen offset:3072 nt lds
    s_mov_b32 s30, 1572864
    s_mov_b32 s31, 0x20000
    s_mov_b32 s34, 524288
    s_mov_b32 s35, 0x20000
    s_mov_b32 s38, 1835008
    s_mov_b32 s39, 0x20000
    s_mov_b32 s42, 1835008
    s_mov_b32 s43, 0x20000
    s_mov_b32 s46, 2097152
    s_mov_b32 s47, 0x20000
    s_mov_b32 s50, 12582912
    s_mov_b32 s51, 0x20000
    s_mov_b32 s54, 12582912
    s_mov_b32 s55, 0x20000
    s_mov_b32 s58, 0
    s_mov_b32 s59, 0x20000
    s_mov_b32 s62, 256
    s_mov_b32 s63, 0x20000
    v_and_b32 v12, 15, v0
    v_lshrrev_b32 v13, 4, v0
    v_lshrrev_b32 v10, 3, v0
    v_mul_u32_u24 v86, 3072, v10
    v_and_b32 v10, 1, v13
    s_and_b32 s76, s68, 1
    s_lshl_b32 s76, s76, 1
    v_or_b32 v10, s76, v10
    v_bfe_u32 v14, v0, 1, 2
    v_xor_b32 v10, v10, v14
    v_lshl_add_u32 v86, v10, 5, v86
    v_and_b32 v10, 1, v0
    v_lshl_add_u32 v86, v10, 4, v86
    s_mul_i32 s81, s68, 3072
    s_add_u32 s81, s81, 2048
    s_mul_i32 s86, s68, 24576
    s_lshl_b32 s76, s72, 7
    s_add_u32 s86, s86, s76
    s_mul_i32 s87, s19, 196608
    s_add_u32 s82, s87, s86
    s_add_u32 s86, s86, 1572864
    s_lshr_b32 s76, s2, 3
    s_lshl_b32 s76, s76, 2
    s_add_u32 s76, s76, s68
    s_mul_i32 s76, s76, 12288
    v_lshlrev_b32 v10, 10, v0
    s_mov_b64 exec, 4095
    buffer_load_dword v231, v10, s[28:31], s76 offen offset:384
    s_mov_b64 exec, -1
    s_lshl_b32 s74, s69, 12
    s_add_u32 s74, s74, 11927552
    s_lshl_b32 s76, s70, 2
    s_add_u32 s76, s76, s68
    s_cmp_eq_u32 s76, 0
    s_cselect_b64 s[14:15], -1, 0
    s_lshl_b32 s76, s76, 2
    v_mov_b32 v11, s76
    s_or_b32 s9, s73, 0x80
    v_mov_b32 v96, 0
    v_mov_b32 v97, 0
    v_mov_b32 v98, 0
    v_mov_b32 v99, 0
    s_mov_b64 exec, s[14:15]
    buffer_store_dwordx4 v[96:99], v1, s[48:51], s74 offen sc1
    s_mov_b64 exec, -1
    v_lshlrev_b32 v81, 10, v13
    v_lshl_add_u32 v81, v12, 4, v81
    v_lshlrev_b32 v10, 1, v13
    v_cmp_lt_u32 vcc, v12, v10
    v_add_u32 v14, 1024, v81
    v_add_u32 v79, 75776, v1
    v_cndmask_b32 v95, v81, v14, vcc
    v_mul_u32_u24 v10, 1056, v12
    v_lshl_add_u32 v10, v13, 4, v10
    v_add_u32 v82, 75776, v10
    v_add_u32 v83, 126464, v10
    v_lshrrev_b32 v10, 2, v12
    v_mad_u32_u24 v10, v13, 24, v10
    v_lshlrev_b32 v84, 7, v10
    v_lshrrev_b32 v10, 3, v12
    v_and_b32 v14, 1, v13
    v_lshl_or_b32 v10, v14, 1, v10
    v_xor_b32 v10, s68, v10
    v_lshl_add_u32 v84, v10, 5, v84
    v_and_b32 v10, 3, v12
    v_lshl_add_u32 v84, v10, 3, v84
    v_add_u32 v84, 2048, v84
    v_add_u32 v85, 36864, v84
    s_mul_i32 s76, s68, 80
    v_lshl_add_u32 v87, v13, 2, s76
    v_lshrrev_b32 v10, 3, v12
    v_bfe_u32 v14, v12, 2, 1
    v_lshl_add_u32 v10, v14, 1, v10
    v_and_b32 v14, 1, v12
    v_lshl_add_u32 v10, v14, 2, v10
    v_add_u32 v10, s79, v10
    v_subrev_u32 v14, 5, v10
    v_min_u32 v10, v10, v14
    v_lshl_add_u32 v87, v10, 4, v87
    v_lshlrev_b32 v88, 2, v12
    v_lshlrev_b32 v89, 4, v13
    s_lshl_b32 s76, s69, 2
    v_mov_b32 v91, s76
    s_mov_b32 s80, 1065369472
    v_mov_b32 v94, 4048155338
    v_mov_b32 v10, 0
    s_cmp_eq_u32 s71, 0
    s_cselect_b64 s[88:89], -1, 0
    s_mov_b32 vcc_lo, 1431328085
    s_mov_b32 vcc_hi, 1342199040
    v_cndmask_b32 v244, v94, v10, vcc
    s_mov_b32 vcc_lo, 327680
    s_mov_b32 vcc_hi, 89456725
    v_cndmask_b32 v240, v94, v10, vcc
    v_cndmask_b32 v248, v240, v94, s[88:89]
    s_mov_b32 vcc_lo, 2862656170
    s_mov_b32 vcc_hi, 2684398080
    v_cndmask_b32 v245, v94, v10, vcc
    s_mov_b32 vcc_lo, 655360
    s_mov_b32 vcc_hi, 178913450
    v_cndmask_b32 v241, v94, v10, vcc
    v_cndmask_b32 v249, v241, v94, s[88:89]
    s_mov_b32 vcc_lo, 1430279508
    s_mov_b32 vcc_hi, 1073763328
    v_cndmask_b32 v246, v94, v10, vcc
    s_mov_b32 vcc_lo, 1376257
    s_mov_b32 vcc_hi, 357892437
    v_cndmask_b32 v242, v94, v10, vcc
    v_cndmask_b32 v250, v242, v94, s[88:89]
    s_mov_b32 vcc_lo, 2860559016
    s_mov_b32 vcc_hi, 2147526656
    v_cndmask_b32 v247, v94, v10, vcc
    s_mov_b32 vcc_lo, 2752514
    s_mov_b32 vcc_hi, 715784874
    v_cndmask_b32 v243, v94, v10, vcc
    v_cndmask_b32 v251, v243, v94, s[88:89]
    v_and_b32 v14, 1, v12
    v_lshlrev_b32 v14, 4, v14
    s_mov_b32 s76, 0xffff
    v_lshlrev_b32 v94, v14, s76
    s_mov_b32 vcc_lo, 4293984255
    s_mov_b32 vcc_hi, 4026597120
    v_cndmask_b32 v252, v10, v94, vcc
    v_cndmask_b32 v254, v94, v10, vcc
    s_mov_b32 vcc_lo, 4290838524
    s_mov_b32 vcc_hi, 3221289984
    v_cndmask_b32 v253, v10, v94, vcc
    v_cndmask_b32 v255, v94, v10, vcc
    v_mov_b32 v232, s80
    v_mov_b32 v233, s80
    v_mov_b32 v234, s80
    v_mov_b32 v235, s80
    v_lshrrev_b32 v10, 3, v0
    v_and_b32 v14, 2, v10
    v_bfe_u32 v224, v0, 1, 2
    v_xor_b32 v14, v14, v224
    v_lshlrev_b32 v14, 5, v14
    v_and_b32 v224, 1, v0
    v_lshl_add_u32 v14, v224, 4, v14
    v_lshl_add_u32 v210, v10, 10, v14
    v_and_b32 v224, 4, v10
    v_add_u32 v10, v10, v224
    v_lshl_add_u32 v224, v10, 10, v14
    v_lshrrev_b32 v10, 5, v0
    v_lshlrev_b32 v220, 4, v10
    v_bfe_u32 v14, v0, 2, 2
    v_lshl_add_u32 v10, v10, 2, v14
    v_lshlrev_b32 v208, 7, v10
    v_and_b32 v10, 3, v0
    v_lshl_add_u32 v208, v10, 3, v208
    v_mov_b32 v212, v208
    v_and_b32 v10, 2, v14
    v_bfe_u32 v14, v0, 4, 1
    v_xor_b32 v10, v10, v14
    s_and_b32 s77, s68, 1
    s_lshl_b32 s76, s77, 1
    v_xor_b32 v10, s76, v10
    v_lshl_add_u32 v208, v10, 5, v208
    v_add_u32 v226, s81, v208
    v_xor_b32 v227, 64, v226
    s_lshl_b32 s3, s68, 11
    v_add_u32 v208, s3, v208
    v_xor_b32 v209, 64, v208
    v_bfe_u32 v14, v0, 4, 1
    v_lshrrev_b32 v10, 3, v0
    v_mul_u32_u24 v211, 3584, v10
    v_and_b32 v10, 7, v0
    v_lshlrev_b32 v225, 2, v10
    s_and_b32 s76, s68, 2
    v_or_b32 v10, s76, v14
    v_bfe_u32 v14, v0, 1, 2
    v_xor_b32 v10, v10, v14
    v_lshl_add_u32 v211, v10, 5, v211
    v_and_b32 v10, 1, v0
    v_lshl_add_u32 v211, v10, 4, v211
    s_and_b32 s77, s68, 1
    s_mov_b32 s5, s70
    v_mov_b32 v230, s5
    s_min_u32 s78, s5, 13
    s_mul_i32 s5, s77, 57344
    s_and_b32 s76, s78, 15
    s_lshl_b32 s76, s76, 8
    s_add_u32 s5, s5, s76
    s_mul_i32 s4, s94, 229376
    s_add_u32 s4, s4, s5
    s_mov_b32 s20, s5
    s_add_u32 s5, s5, 1835008
    s_mov_b32 s16, s4
    s_add_u32 s4, s4, 114688
    s_cmp_ge_u32 s4, s5
    s_cselect_b32 s4, s20, s4
    s_mov_b32 s17, s4
    s_add_u32 s4, s4, 114688
    s_cmp_ge_u32 s4, s5
    s_cselect_b32 s4, s20, s4
    s_mov_b32 s18, s4
    s_add_u32 s4, s4, 114688
    s_cmp_ge_u32 s4, s5
    s_cselect_b32 s4, s20, s4
    s_mov_b32 s21, s4
    s_add_u32 s4, s4, 114688
    s_cmp_ge_u32 s4, s5
    s_cselect_b32 s4, s20, s4
    s_mov_b32 s22, s4
    s_add_u32 s4, s4, 114688
    s_cmp_ge_u32 s4, s5
    s_cselect_b32 s4, s20, s4
    s_mov_b32 s64, s4
    s_add_u32 s4, s4, 114688
    s_cmp_ge_u32 s4, s5
    s_cselect_b32 s4, s20, s4
    s_mov_b32 s65, s4
    s_add_u32 s4, s4, 114688
    s_cmp_ge_u32 s4, s5
    s_cselect_b32 s4, s20, s4
    s_mov_b32 s66, s4
    s_add_u32 s4, s4, 114688
    s_cmp_ge_u32 s4, s5
    s_cselect_b32 s4, s20, s4
    s_mov_b32 s67, s4
    s_add_u32 s4, s4, 114688
    s_cmp_ge_u32 s4, s5
    s_cselect_b32 s4, s20, s4
    s_mov_b32 s95, s4
    s_add_u32 s4, s4, 114688
    s_cmp_ge_u32 s4, s5
    s_cselect_b32 s4, s20, s4
    s_mov_b32 s96, s4
    s_add_u32 s4, s4, 114688
    s_cmp_ge_u32 s4, s5
    s_cselect_b32 s4, s20, s4
    s_mov_b32 s88, s4
    s_add_u32 s4, s4, 114688
    s_cmp_ge_u32 s4, s5
    s_cselect_b32 s4, s20, s4
    s_mov_b32 s89, s4
    s_add_u32 s4, s4, 114688
    s_cmp_ge_u32 s4, s5
    s_cselect_b32 s4, s20, s4
    s_mov_b32 s90, s4
    s_add_u32 s4, s4, 114688
    s_cmp_ge_u32 s4, s5
    s_cselect_b32 s4, s20, s4
    s_mov_b32 s91, s4
    s_add_u32 s4, s4, 114688
    s_cmp_ge_u32 s4, s5
    s_cselect_b32 s4, s20, s4
    s_mov_b32 s1, s4
    s_lshl_b32 s6, s71, 4
    s_add_u32 s6, s6, s72
    s_lshl_b32 s6, s6, 12
    s_lshr_b32 s12, s68, 1
    s_lshl_b32 s76, s12, 15
    s_add_u32 s8, s6, s76
    s_lshl_b32 s76, s77, 11
    s_add_u32 s8, s8, s76
    s_add_u32 s8, s8, 2097152
    s_lshl_b32 s76, s68, 10
    s_add_u32 s6, s6, s76
    v_and_b32 v10, 31, v0
    v_mul_u32_u24 v10, 1056, v10
    v_lshrrev_b32 v14, 1, v220
    v_add_u32 v10, v10, v14
    s_lshl_b32 s76, s72, 1
    s_add_u32 s76, s76, s77
    s_lshl_b32 s77, s19, 1
    s_sub_u32 s76, s76, s77
    s_and_b32 s76, s76, 15
    s_lshl_b32 s76, s76, 6
    s_mul_i32 s77, s12, 33792
    s_add_u32 s76, s76, s77
    s_add_u32 s76, s76, 92672
    v_add_u32 v90, s76, v10
    s_and_b32 s78, s70, 8
    s_lshl_b32 s77, s68, 1
    s_add_u32 s76, s78, s77
    s_lshl_b32 s76, s76, 4
    v_add_u32 v225, s76, v225
    v_and_b32 v10, 7, v0
    v_lshlrev_b32 v229, 7, v10
    v_bfe_u32 v10, v0, 3, 1
    v_lshl_add_u32 v229, v10, 15, v229
    v_add_u32 v14, 28672, v211
    v_add_u32 v238, 4096, v224
    s_lshl_b32 s23, s2, 2
    s_add_u32 s23, s23, s68
    v_lshlrev_b32 v239, 7, v0
    s_add_u32 s75, s75, 4
    s_cmp_ge_u32 s75, 20
    s_cselect_b32 s75, 0, s75
    s_mul_i32 s100, s75, 1056
    s_add_u32 s100, s100, s85
    s_add_u32 s76, s75, s97
    s_max_i32 s76, s76, 0
    s_mov_b32 m0, s100
    s_lshl_b32 s76, s76, 10
    buffer_load_dwordx4 v76, s[24:27], s76 offen offset:0 nt lds
    s_add_u32 m0, s100, 32
    s_nop 0
    buffer_load_dwordx4 v76, s[24:27], s76 offen offset:1024 nt lds
    s_add_u32 m0, s100, 64
    s_nop 0
    buffer_load_dwordx4 v76, s[24:27], s76 offen offset:2048 nt lds
    s_add_u32 m0, s100, 96
    s_nop 0
    buffer_load_dwordx4 v76, s[24:27], s76 offen offset:3072 nt lds
    v_add_u32 v77, s98, v81
    v_add_u32 v78, s98, v95
    s_waitcnt vmcnt(10)
    ds_read_b128 v[96:99], v78 offset:0
    ds_read_b128 v[100:103], v77 offset:256
    ds_read_b128 v[104:107], v77 offset:512
    ds_read_b128 v[108:111], v77 offset:768
    s_add_u32 s75, s75, 4
    s_cmp_ge_u32 s75, 20
    s_cselect_b32 s75, 0, s75
    s_mul_i32 s98, s75, 1056
    s_add_u32 s98, s98, s85
    s_add_u32 s76, s75, s97
    s_max_i32 s76, s76, 0
    s_mov_b32 m0, s98
    s_lshl_b32 s76, s76, 10
    buffer_load_dwordx4 v76, s[24:27], s76 offen offset:0 nt lds
    s_add_u32 m0, s98, 32
    s_nop 0
    buffer_load_dwordx4 v76, s[24:27], s76 offen offset:1024 nt lds
    s_add_u32 m0, s98, 64
    s_nop 0
    buffer_load_dwordx4 v76, s[24:27], s76 offen offset:2048 nt lds
    s_add_u32 m0, s98, 96
    s_nop 0
    buffer_load_dwordx4 v76, s[24:27], s76 offen offset:3072 nt lds
    s_waitcnt lgkmcnt(2)
    v_dot2_f32_bf16 v176, v96, s80, 0
    v_dot2_f32_bf16 v177, v96, v96, 0
    v_dot2_f32_bf16 v176, v97, s80, v176
    v_dot2_f32_bf16 v177, v97, v97, v177
    v_dot2_f32_bf16 v176, v98, s80, v176
    v_dot2_f32_bf16 v177, v98, v98, v177
    v_dot2_f32_bf16 v176, v99, s80, v176
    v_dot2_f32_bf16 v177, v99, v99, v177
    v_dot2_f32_bf16 v176, v100, s80, v176
    v_dot2_f32_bf16 v177, v100, v100, v177
    v_dot2_f32_bf16 v176, v101, s80, v176
    v_dot2_f32_bf16 v177, v101, v101, v177
    v_dot2_f32_bf16 v176, v102, s80, v176
    v_dot2_f32_bf16 v177, v102, v102, v177
    v_dot2_f32_bf16 v176, v103, s80, v176
    v_dot2_f32_bf16 v177, v103, v103, v177
    s_waitcnt lgkmcnt(0)
    v_dot2_f32_bf16 v176, v104, s80, v176
    v_dot2_f32_bf16 v177, v104, v104, v177
    v_dot2_f32_bf16 v176, v105, s80, v176
    v_dot2_f32_bf16 v177, v105, v105, v177
    v_dot2_f32_bf16 v176, v106, s80, v176
    v_dot2_f32_bf16 v177, v106, v106, v177
    v_dot2_f32_bf16 v176, v107, s80, v176
    v_dot2_f32_bf16 v177, v107, v107, v177
    v_dot2_f32_bf16 v176, v108, s80, v176
    v_dot2_f32_bf16 v177, v108, v108, v177
    v_dot2_f32_bf16 v176, v109, s80, v176
    v_dot2_f32_bf16 v177, v109, v109, v177
    v_dot2_f32_bf16 v176, v110, s80, v176
    v_dot2_f32_bf16 v177, v110, v110, v177
    v_dot2_f32_bf16 v176, v111, s80, v176
    v_dot2_f32_bf16 v177, v111, v111, v177
    v_add_u32 v77, s99, v81
    v_add_u32 v78, s99, v95
    s_waitcnt vmcnt(10)
    ds_read_b128 v[112:115], v78 offset:0
    ds_read_b128 v[116:119], v77 offset:256
    ds_read_b128 v[120:123], v77 offset:512
    ds_read_b128 v[124:127], v77 offset:768
    s_add_u32 s75, s75, 4
    s_cmp_ge_u32 s75, 20
    s_cselect_b32 s75, 0, s75
    s_mul_i32 s99, s75, 1056
    s_add_u32 s99, s99, s85
    s_add_u32 s76, s75, s97
    s_max_i32 s76, s76, 0
    s_mov_b32 m0, s99
    s_lshl_b32 s76, s76, 10
    buffer_load_dwordx4 v76, s[24:27], s76 offen offset:0 nt lds
    s_add_u32 m0, s99, 32
    s_nop 0
    buffer_load_dwordx4 v76, s[24:27], s76 offen offset:1024 nt lds
    s_add_u32 m0, s99, 64
    s_nop 0
    buffer_load_dwordx4 v76, s[24:27], s76 offen offset:2048 nt lds
    s_add_u32 m0, s99, 96
    s_nop 0
    buffer_load_dwordx4 v76, s[24:27], s76 offen offset:3072 nt lds
    s_waitcnt lgkmcnt(2)
    v_dot2_f32_bf16 v178, v112, s80, 0
    v_dot2_f32_bf16 v179, v112, v112, 0
    v_dot2_f32_bf16 v178, v113, s80, v178
    v_dot2_f32_bf16 v179, v113, v113, v179
    v_dot2_f32_bf16 v178, v114, s80, v178
    v_dot2_f32_bf16 v179, v114, v114, v179
    v_dot2_f32_bf16 v178, v115, s80, v178
    v_dot2_f32_bf16 v179, v115, v115, v179
    v_dot2_f32_bf16 v178, v116, s80, v178
    v_dot2_f32_bf16 v179, v116, v116, v179
    v_dot2_f32_bf16 v178, v117, s80, v178
    v_dot2_f32_bf16 v179, v117, v117, v179
    v_dot2_f32_bf16 v178, v118, s80, v178
    v_dot2_f32_bf16 v179, v118, v118, v179
    v_dot2_f32_bf16 v178, v119, s80, v178
    v_dot2_f32_bf16 v179, v119, v119, v179
    s_waitcnt lgkmcnt(0)
    v_dot2_f32_bf16 v178, v120, s80, v178
    v_dot2_f32_bf16 v179, v120, v120, v179
    v_dot2_f32_bf16 v178, v121, s80, v178
    v_dot2_f32_bf16 v179, v121, v121, v179
    v_dot2_f32_bf16 v178, v122, s80, v178
    v_dot2_f32_bf16 v179, v122, v122, v179
    v_dot2_f32_bf16 v178, v123, s80, v178
    v_dot2_f32_bf16 v179, v123, v123, v179
    v_dot2_f32_bf16 v178, v124, s80, v178
    v_dot2_f32_bf16 v179, v124, v124, v179
    v_dot2_f32_bf16 v178, v125, s80, v178
    v_dot2_f32_bf16 v179, v125, v125, v179
    v_dot2_f32_bf16 v178, v126, s80, v178
    v_dot2_f32_bf16 v179, v126, v126, v179
    v_dot2_f32_bf16 v178, v127, s80, v178
    v_dot2_f32_bf16 v179, v127, v127, v179
    s_add_u32 m0, s81, 0
    s_nop 0
    buffer_load_dwordx4 v86, s[28:31], s82 offen offset:0 lds
    buffer_load_dwordx4 v86, s[28:31], s82 offen offset:1024 lds
    buffer_load_dwordx4 v86, s[28:31], s82 offen offset:2048 lds
    v_add_u32 v77, s100, v81
    v_add_u32 v78, s100, v95
    s_waitcnt vmcnt(11)
    ds_read_b128 v[96:99], v78 offset:0
    ds_read_b128 v[100:103], v77 offset:256
    ds_read_b128 v[104:107], v77 offset:512
    ds_read_b128 v[108:111], v77 offset:768
    v_mov_b32 v10, 1
    s_and_b64 exec, s[14:15], 1
    buffer_store_dword v10, v91, s[60:63], 0 offen sc1
    s_mov_b64 exec, -1
    s_waitcnt lgkmcnt(2)
    v_dot2_f32_bf16 v180, v96, s80, 0
    v_dot2_f32_bf16 v181, v96, v96, 0
    v_dot2_f32_bf16 v180, v97, s80, v180
    v_dot2_f32_bf16 v181, v97, v97, v181
    v_dot2_f32_bf16 v180, v98, s80, v180
    v_dot2_f32_bf16 v181, v98, v98, v181
    v_dot2_f32_bf16 v180, v99, s80, v180
    v_dot2_f32_bf16 v181, v99, v99, v181
    v_dot2_f32_bf16 v180, v100, s80, v180
    v_dot2_f32_bf16 v181, v100, v100, v181
    v_dot2_f32_bf16 v180, v101, s80, v180
    v_dot2_f32_bf16 v181, v101, v101, v181
    v_dot2_f32_bf16 v180, v102, s80, v180
    v_dot2_f32_bf16 v181, v102, v102, v181
    v_dot2_f32_bf16 v180, v103, s80, v180
    v_dot2_f32_bf16 v181, v103, v103, v181
    s_waitcnt lgkmcnt(0)
    v_dot2_f32_bf16 v180, v104, s80, v180
    v_dot2_f32_bf16 v181, v104, v104, v181
    v_dot2_f32_bf16 v180, v105, s80, v180
    v_dot2_f32_bf16 v181, v105, v105, v181
    v_dot2_f32_bf16 v180, v106, s80, v180
    v_dot2_f32_bf16 v181, v106, v106, v181
    v_dot2_f32_bf16 v180, v107, s80, v180
    v_dot2_f32_bf16 v181, v107, v107, v181
    v_dot2_f32_bf16 v180, v108, s80, v180
    v_dot2_f32_bf16 v181, v108, v108, v181
    v_dot2_f32_bf16 v180, v109, s80, v180
    v_dot2_f32_bf16 v181, v109, v109, v181
    v_dot2_f32_bf16 v180, v110, s80, v180
    v_dot2_f32_bf16 v181, v110, v110, v181
    v_dot2_f32_bf16 v180, v111, s80, v180
    v_dot2_f32_bf16 v181, v111, v111, v181
    v_add_u32 v77, s98, v81
    v_add_u32 v78, s98, v95
    s_waitcnt vmcnt(8)
    ds_read_b128 v[112:115], v78 offset:0
    ds_read_b128 v[116:119], v77 offset:256
    ds_read_b128 v[120:123], v77 offset:512
    ds_read_b128 v[124:127], v77 offset:768
    s_add_u32 s82, s82, 98304
    s_cmp_ge_u32 s82, s86
    s_cselect_b32 s87, 1572864, 0
    s_sub_u32 s82, s82, s87
    s_add_u32 m0, s81, 12288
    s_nop 0
    buffer_load_dwordx4 v86, s[28:31], s82 offen offset:0 lds
    buffer_load_dwordx4 v86, s[28:31], s82 offen offset:1024 lds
    buffer_load_dwordx4 v86, s[28:31], s82 offen offset:2048 lds
    s_waitcnt lgkmcnt(2)
    v_dot2_f32_bf16 v182, v112, s80, 0
    v_dot2_f32_bf16 v183, v112, v112, 0
    v_dot2_f32_bf16 v182, v113, s80, v182
    v_dot2_f32_bf16 v183, v113, v113, v183
    v_dot2_f32_bf16 v182, v114, s80, v182
    v_dot2_f32_bf16 v183, v114, v114, v183
    v_dot2_f32_bf16 v182, v115, s80, v182
    v_dot2_f32_bf16 v183, v115, v115, v183
    v_dot2_f32_bf16 v182, v116, s80, v182
    v_dot2_f32_bf16 v183, v116, v116, v183
    v_dot2_f32_bf16 v182, v117, s80, v182
    v_dot2_f32_bf16 v183, v117, v117, v183
    v_dot2_f32_bf16 v182, v118, s80, v182
    v_dot2_f32_bf16 v183, v118, v118, v183
    v_dot2_f32_bf16 v182, v119, s80, v182
    v_dot2_f32_bf16 v183, v119, v119, v183
    s_waitcnt lgkmcnt(0)
    v_dot2_f32_bf16 v182, v120, s80, v182
    v_dot2_f32_bf16 v183, v120, v120, v183
    v_dot2_f32_bf16 v182, v121, s80, v182
    v_dot2_f32_bf16 v183, v121, v121, v183
    v_dot2_f32_bf16 v182, v122, s80, v182
    v_dot2_f32_bf16 v183, v122, v122, v183
    v_dot2_f32_bf16 v182, v123, s80, v182
    v_dot2_f32_bf16 v183, v123, v123, v183
    v_dot2_f32_bf16 v182, v124, s80, v182
    v_dot2_f32_bf16 v183, v124, v124, v183
    v_dot2_f32_bf16 v182, v125, s80, v182
    v_dot2_f32_bf16 v183, v125, v125, v183
    v_dot2_f32_bf16 v182, v126, s80, v182
    v_dot2_f32_bf16 v183, v126, v126, v183
    v_dot2_f32_bf16 v182, v127, s80, v182
    v_dot2_f32_bf16 v183, v127, v127, v183
    v_add_u32 v77, s99, v81
    v_add_u32 v78, s99, v95
    s_waitcnt vmcnt(7)
    ds_read_b128 v[96:99], v78 offset:0
    ds_read_b128 v[100:103], v77 offset:256
    ds_read_b128 v[104:107], v77 offset:512
    ds_read_b128 v[108:111], v77 offset:768
    s_add_u32 s82, s82, 98304
    s_cmp_ge_u32 s82, s86
    s_cselect_b32 s87, 1572864, 0
    s_sub_u32 s82, s82, s87
    s_add_u32 m0, s81, 24576
    s_nop 0
    buffer_load_dwordx4 v86, s[28:31], s82 offen offset:0 lds
    buffer_load_dwordx4 v86, s[28:31], s82 offen offset:1024 lds
    buffer_load_dwordx4 v86, s[28:31], s82 offen offset:2048 lds
    s_waitcnt lgkmcnt(2)
    v_dot2_f32_bf16 v184, v96, s80, 0
    v_dot2_f32_bf16 v185, v96, v96, 0
    v_dot2_f32_bf16 v184, v97, s80, v184
    v_dot2_f32_bf16 v185, v97, v97, v185
    v_dot2_f32_bf16 v184, v98, s80, v184
    v_dot2_f32_bf16 v185, v98, v98, v185
    v_dot2_f32_bf16 v184, v99, s80, v184
    v_dot2_f32_bf16 v185, v99, v99, v185
    v_dot2_f32_bf16 v184, v100, s80, v184
    v_dot2_f32_bf16 v185, v100, v100, v185
    v_dot2_f32_bf16 v184, v101, s80, v184
    v_dot2_f32_bf16 v185, v101, v101, v185
    v_dot2_f32_bf16 v184, v102, s80, v184
    v_dot2_f32_bf16 v185, v102, v102, v185
    v_dot2_f32_bf16 v184, v103, s80, v184
    v_dot2_f32_bf16 v185, v103, v103, v185
    s_waitcnt lgkmcnt(0)
    v_dot2_f32_bf16 v184, v104, s80, v184
    v_dot2_f32_bf16 v185, v104, v104, v185
    v_dot2_f32_bf16 v184, v105, s80, v184
    v_dot2_f32_bf16 v185, v105, v105, v185
    v_dot2_f32_bf16 v184, v106, s80, v184
    v_dot2_f32_bf16 v185, v106, v106, v185
    v_dot2_f32_bf16 v184, v107, s80, v184
    v_dot2_f32_bf16 v185, v107, v107, v185
    v_dot2_f32_bf16 v184, v108, s80, v184
    v_dot2_f32_bf16 v185, v108, v108, v185
    v_dot2_f32_bf16 v184, v109, s80, v184
    v_dot2_f32_bf16 v185, v109, v109, v185
    v_dot2_f32_bf16 v184, v110, s80, v184
    v_dot2_f32_bf16 v185, v110, v110, v185
    v_dot2_f32_bf16 v184, v111, s80, v184
    v_dot2_f32_bf16 v185, v111, v111, v185
    s_cmp_eq_u32 s68, 0
    s_cselect_b64 exec, -1, 0
    ds_write_b128 v79, v[232:235]
    s_mov_b64 exec, -1
    s_add_u32 s82, s82, 98304
    s_cmp_ge_u32 s82, s86
    s_cselect_b32 s87, 1572864, 0
    s_sub_u32 s82, s82, s87
    s_add_u32 m0, s81, 36864
    s_nop 0
    buffer_load_dwordx4 v86, s[28:31], s82 offen offset:0 lds
    buffer_load_dwordx4 v86, s[28:31], s82 offen offset:1024 lds
    buffer_load_dwordx4 v86, s[28:31], s82 offen offset:2048 lds
    v_add_f32_dpp v176, v176, v176 row_ror:8 row_mask:0xf bank_mask:0xf
    v_add_f32_dpp v180, v180, v180 row_ror:8 row_mask:0xf bank_mask:0xf
    v_add_f32_dpp v184, v184, v184 row_ror:8 row_mask:0xf bank_mask:0xf
    v_add_f32_dpp v177, v177, v177 row_ror:8 row_mask:0xf bank_mask:0xf
    v_add_f32_dpp v181, v181, v181 row_ror:8 row_mask:0xf bank_mask:0xf
    v_add_f32_dpp v185, v185, v185 row_ror:8 row_mask:0xf bank_mask:0xf
    v_add_f32_dpp v176, v178, v178 row_ror:8 row_mask:0xf bank_mask:0xc
    v_add_f32_dpp v180, v182, v182 row_ror:8 row_mask:0xf bank_mask:0xc
    v_add_f32_dpp v177, v179, v179 row_ror:8 row_mask:0xf bank_mask:0xc
    v_add_f32_dpp v181, v183, v183 row_ror:8 row_mask:0xf bank_mask:0xc
    v_add_f32_dpp v184, v184, v184 row_half_mirror row_mask:0xf bank_mask:0xf
    v_add_f32_dpp v185, v185, v185 row_half_mirror row_mask:0xf bank_mask:0xf
    v_add_f32_dpp v176, v176, v176 row_half_mirror row_mask:0xf bank_mask:0xf
    v_add_f32_dpp v177, v177, v177 row_half_mirror row_mask:0xf bank_mask:0xf
    s_nop 0
    v_add_f32_dpp v176, v180, v180 row_half_mirror row_mask:0xf bank_mask:0xa
    v_add_f32_dpp v177, v181, v181 row_half_mirror row_mask:0xf bank_mask:0xa
    v_add_f32_dpp v184, v184, v184 quad_perm:[1,0,3,2] row_mask:0xf bank_mask:0xf
    v_add_f32_dpp v185, v185, v185 quad_perm:[1,0,3,2] row_mask:0xf bank_mask:0xf
    v_add_f32_dpp v176, v176, v176 quad_perm:[1,0,3,2] row_mask:0xf bank_mask:0xf
    v_add_f32_dpp v177, v177, v177 quad_perm:[1,0,3,2] row_mask:0xf bank_mask:0xf
    v_add_f32_dpp v184, v184, v184 quad_perm:[2,3,0,1] row_mask:0xf bank_mask:0xf
    v_add_f32_dpp v185, v185, v185 quad_perm:[2,3,0,1] row_mask:0xf bank_mask:0xf
    v_add_f32_dpp v176, v176, v176 quad_perm:[2,3,0,1] row_mask:0xf bank_mask:0xf
    v_add_f32_dpp v177, v177, v177 quad_perm:[2,3,0,1] row_mask:0xf bank_mask:0xf
    s_mov_b32 vcc_lo, 0x00020002
    s_mov_b32 vcc_hi, 0x00020002
    v_cndmask_b32 v176, v176, v184, vcc
    v_cndmask_b32 v177, v177, v185, vcc
    v_mul_f32 v176, 3137339392, v176
    v_mul_f32 v177, 989855744, v177
    v_fma_f32 v177, -v176, v176, v177
    v_max_f32 v177, 0, v177
    v_add_f32 v177, 925353388, v177
    v_rsq_f32 v177, v177
    s_mov_b32 exec_lo, 0x11131113
    s_mov_b32 exec_hi, 0x11131113
    ds_write2_b32 v87, v176, v177 offset0:0 offset1:80
    s_mov_b64 exec, -1
    s_waitcnt vmcnt(10) lgkmcnt(0)
    s_barrier
    ds_read_b64_tr_b16 a[40:41], v84 offset:0
    ds_read_b64_tr_b16 a[42:43], v84 offset:512
    ds_read_b128 a[0:3], v82 offset:0
    ds_read_b64_tr_b16 a[44:45], v84 offset:1024
    ds_read_b64_tr_b16 a[46:47], v84 offset:1536
    ds_read_b64_tr_b16 a[48:49], v84 offset:2048
    ds_read_b64_tr_b16 a[50:51], v84 offset:2560
    ds_read_b128 a[4:7], v82 offset:16896
    ds_read_b128 a[8:11], v82 offset:33792
    ds_read_b128 a[12:15], v83 offset:0
    ds_read_b128 a[16:19], v83 offset:16896
    s_add_u32 s82, s82, 98304
    s_cmp_ge_u32 s82, s86
    s_cselect_b32 s87, 1572864, 0
    s_sub_u32 s82, s82, s87
    s_add_u32 m0, s81, 49152
    s_nop 0
    buffer_load_dwordx4 v86, s[28:31], s82 offen offset:0 lds
    buffer_load_dwordx4 v86, s[28:31], s82 offen offset:1024 lds
    buffer_load_dwordx4 v86, s[28:31], s82 offen offset:2048 lds
    s_add_u32 s82, s82, 98304
    s_cmp_ge_u32 s82, s86
    s_cselect_b32 s87, 1572864, 0
    s_sub_u32 s82, s82, s87
    s_add_u32 m0, s81, 61440
    s_nop 0
    buffer_load_dwordx4 v86, s[28:31], s82 offen offset:0 lds
    buffer_load_dwordx4 v86, s[28:31], s82 offen offset:1024 lds
    buffer_load_dwordx4 v86, s[28:31], s82 offen offset:2048 lds
    s_add_u32 s82, s82, 98304
    s_cmp_ge_u32 s82, s86
    s_cselect_b32 s87, 1572864, 0
    s_sub_u32 s82, s82, s87
    s_add_u32 m0, s81, 0
    s_waitcnt lgkmcnt(4)
    v_mfma_f32_16x16x32_bf16 v[16:19], a[40:43], v[232:235], 0
    s_waitcnt vmcnt(12)
    s_barrier
    v_mfma_f32_16x16x32_bf16 v[36:39], a[44:47], a[0:3], 0
    buffer_load_dwordx4 v86, s[28:31], s82 offen offset:0 lds
    v_mfma_f32_16x16x32_bf16 v[56:59], a[0:3], a[48:51], 0
    ds_read_b64_tr_b16 a[52:53], v84 offset:12288
    s_waitcnt lgkmcnt(3)
    v_mfma_f32_16x16x32_bf16 v[20:23], a[40:43], a[4:7], 0
    ds_read_b64_tr_b16 a[54:55], v84 offset:12800
    v_mfma_f32_16x16x32_bf16 v[40:43], a[44:47], a[4:7], 0
    ds_read_b128 a[20:23], v82 offset:64
    v_mfma_f32_16x16x32_bf16 v[60:63], a[4:7], a[48:51], 0
    buffer_load_dwordx4 v86, s[28:31], s82 offen offset:1024 lds
    v_mfma_f32_16x16x32_bf16 v[24:27], a[40:43], a[8:11], 0
    ds_read_b64_tr_b16 a[56:57], v84 offset:13312
    v_mfma_f32_16x16x32_bf16 v[44:47], a[44:47], a[8:11], 0
    ds_read_b64_tr_b16 a[58:59], v84 offset:13824
    v_mfma_f32_16x16x32_bf16 v[64:67], a[8:11], a[48:51], 0
    ds_read_b64_tr_b16 a[60:61], v84 offset:14336
    s_waitcnt lgkmcnt(6)
    v_mfma_f32_16x16x32_bf16 v[28:31], a[40:43], a[12:15], 0
    buffer_load_dwordx4 v86, s[28:31], s82 offen offset:2048 lds
    v_mfma_f32_16x16x32_bf16 v[48:51], a[44:47], a[12:15], 0
    ds_read_b64_tr_b16 a[62:63], v84 offset:14848
    s_add_u32 s82, s82, 98304
    v_mfma_f32_16x16x32_bf16 v[68:71], a[12:15], a[48:51], 0
    ds_read_b128 a[24:27], v82 offset:16960
    s_cmp_ge_u32 s82, s86
    s_cselect_b32 s87, 1572864, 0
    v_mfma_f32_16x16x32_bf16 v[32:35], a[40:43], a[16:19], 0
    ds_read_b128 a[28:31], v82 offset:33856
    s_sub_u32 s82, s82, s87
    v_mfma_f32_16x16x32_bf16 v[52:55], a[44:47], a[16:19], 0
    ds_read_b128 a[32:35], v83 offset:64
    s_add_u32 m0, s81, 12288
    v_mfma_f32_16x16x32_bf16 v[72:75], a[16:19], a[48:51], 0
    ds_read_b128 a[36:39], v83 offset:16960
    s_waitcnt lgkmcnt(4)
    v_mfma_f32_16x16x32_bf16 v[16:19], a[52:55], v[232:235], v[16:19]
    s_waitcnt vmcnt(12)
    s_barrier
    v_mfma_f32_16x16x32_bf16 v[36:39], a[56:59], a[20:23], v[36:39]
    buffer_load_dwordx4 v86, s[28:31], s82 offen offset:0 lds
    v_mfma_f32_16x16x32_bf16 v[56:59], a[20:23], a[60:63], v[56:59]
    ds_read_b64_tr_b16 a[40:41], v84 offset:24576
    s_waitcnt lgkmcnt(3)
    v_mfma_f32_16x16x32_bf16 v[20:23], a[52:55], a[24:27], v[20:23]
    ds_read_b64_tr_b16 a[42:43], v84 offset:25088
    v_mfma_f32_16x16x32_bf16 v[40:43], a[56:59], a[24:27], v[40:43]
    ds_read_b128 a[0:3], v82 offset:128
    v_mfma_f32_16x16x32_bf16 v[60:63], a[24:27], a[60:63], v[60:63]
    buffer_load_dwordx4 v86, s[28:31], s82 offen offset:1024 lds
    v_mfma_f32_16x16x32_bf16 v[24:27], a[52:55], a[28:31], v[24:27]
    ds_read_b64_tr_b16 a[44:45], v84 offset:25600
    v_mfma_f32_16x16x32_bf16 v[44:47], a[56:59], a[28:31], v[44:47]
    ds_read_b64_tr_b16 a[46:47], v84 offset:26112
    v_mfma_f32_16x16x32_bf16 v[64:67], a[28:31], a[60:63], v[64:67]
    ds_read_b64_tr_b16 a[48:49], v84 offset:26624
    s_waitcnt lgkmcnt(6)
    v_mfma_f32_16x16x32_bf16 v[28:31], a[52:55], a[32:35], v[28:31]
    buffer_load_dwordx4 v86, s[28:31], s82 offen offset:2048 lds
    v_mfma_f32_16x16x32_bf16 v[48:51], a[56:59], a[32:35], v[48:51]
    ds_read_b64_tr_b16 a[50:51], v84 offset:27136
    s_add_u32 s82, s82, 98304
    v_mfma_f32_16x16x32_bf16 v[68:71], a[32:35], a[60:63], v[68:71]
    ds_read_b128 a[4:7], v82 offset:17024
    s_cmp_ge_u32 s82, s86
    s_cselect_b32 s87, 1572864, 0
    buffer_load_dword v92, v91, s[60:63], 0 offen sc1
    v_mfma_f32_16x16x32_bf16 v[32:35], a[52:55], a[36:39], v[32:35]
    ds_read_b128 a[8:11], v82 offset:33920
    s_sub_u32 s82, s82, s87
    v_mfma_f32_16x16x32_bf16 v[52:55], a[56:59], a[36:39], v[52:55]
    ds_read_b128 a[12:15], v83 offset:128
    s_add_u32 m0, s81, 24576
    v_mfma_f32_16x16x32_bf16 v[72:75], a[36:39], a[60:63], v[72:75]
    ds_read_b128 a[16:19], v83 offset:17024
    s_waitcnt lgkmcnt(4)
    v_mfma_f32_16x16x32_bf16 v[16:19], a[40:43], v[232:235], v[16:19]
    s_waitcnt vmcnt(13)
    s_barrier
    v_mfma_f32_16x16x32_bf16 v[36:39], a[44:47], a[0:3], v[36:39]
    buffer_load_dwordx4 v86, s[28:31], s82 offen offset:0 lds
    v_mfma_f32_16x16x32_bf16 v[56:59], a[0:3], a[48:51], v[56:59]
    ds_read_b64_tr_b16 a[52:53], v85 offset:0
    s_waitcnt lgkmcnt(3)
    v_mfma_f32_16x16x32_bf16 v[20:23], a[40:43], a[4:7], v[20:23]
    ds_read_b64_tr_b16 a[54:55], v85 offset:512
    v_mfma_f32_16x16x32_bf16 v[40:43], a[44:47], a[4:7], v[40:43]
    ds_read_b128 a[20:23], v82 offset:192
    v_mfma_f32_16x16x32_bf16 v[60:63], a[4:7], a[48:51], v[60:63]
    buffer_load_dwordx4 v86, s[28:31], s82 offen offset:1024 lds
    v_mfma_f32_16x16x32_bf16 v[24:27], a[40:43], a[8:11], v[24:27]
    ds_read_b64_tr_b16 a[56:57], v85 offset:1024
    v_mfma_f32_16x16x32_bf16 v[44:47], a[44:47], a[8:11], v[44:47]
    ds_read_b64_tr_b16 a[58:59], v85 offset:1536
    v_mfma_f32_16x16x32_bf16 v[64:67], a[8:11], a[48:51], v[64:67]
    ds_read_b64_tr_b16 a[60:61], v85 offset:2048
    s_waitcnt lgkmcnt(6)
    v_mfma_f32_16x16x32_bf16 v[28:31], a[40:43], a[12:15], v[28:31]
    buffer_load_dwordx4 v86, s[28:31], s82 offen offset:2048 lds
    v_mfma_f32_16x16x32_bf16 v[48:51], a[44:47], a[12:15], v[48:51]
    ds_read_b64_tr_b16 a[62:63], v85 offset:2560
    s_add_u32 s82, s82, 98304
    v_mfma_f32_16x16x32_bf16 v[68:71], a[12:15], a[48:51], v[68:71]
    ds_read_b128 a[24:27], v82 offset:17088
    s_cmp_ge_u32 s82, s86
    s_cselect_b32 s87, 1572864, 0
    v_mfma_f32_16x16x32_bf16 v[32:35], a[40:43], a[16:19], v[32:35]
    ds_read_b128 a[28:31], v82 offset:33984
    s_sub_u32 s82, s82, s87
    v_mfma_f32_16x16x32_bf16 v[52:55], a[44:47], a[16:19], v[52:55]
    ds_read_b128 a[32:35], v83 offset:192
    s_add_u32 m0, s81, 36864
    v_mfma_f32_16x16x32_bf16 v[72:75], a[16:19], a[48:51], v[72:75]
    ds_read_b128 a[36:39], v83 offset:17088
    s_waitcnt lgkmcnt(4)
    v_mfma_f32_16x16x32_bf16 v[16:19], a[52:55], v[232:235], v[16:19]
    s_waitcnt vmcnt(13)
    s_barrier
    v_mfma_f32_16x16x32_bf16 v[36:39], a[56:59], a[20:23], v[36:39]
    buffer_load_dwordx4 v86, s[28:31], s82 offen offset:0 lds
    v_mfma_f32_16x16x32_bf16 v[56:59], a[20:23], a[60:63], v[56:59]
    ds_read_b64_tr_b16 a[40:41], v85 offset:12288
    s_waitcnt lgkmcnt(3)
    v_mfma_f32_16x16x32_bf16 v[20:23], a[52:55], a[24:27], v[20:23]
    ds_read_b64_tr_b16 a[42:43], v85 offset:12800
    v_mfma_f32_16x16x32_bf16 v[40:43], a[56:59], a[24:27], v[40:43]
    ds_read_b128 a[0:3], v82 offset:256
    v_mfma_f32_16x16x32_bf16 v[60:63], a[24:27], a[60:63], v[60:63]
    buffer_load_dwordx4 v86, s[28:31], s82 offen offset:1024 lds
    v_mfma_f32_16x16x32_bf16 v[24:27], a[52:55], a[28:31], v[24:27]
    ds_read_b64_tr_b16 a[44:45], v85 offset:13312
    v_mfma_f32_16x16x32_bf16 v[44:47], a[56:59], a[28:31], v[44:47]
    ds_read_b64_tr_b16 a[46:47], v85 offset:13824
    v_mfma_f32_16x16x32_bf16 v[64:67], a[28:31], a[60:63], v[64:67]
    ds_read_b64_tr_b16 a[48:49], v85 offset:14336
    s_waitcnt lgkmcnt(6)
    v_mfma_f32_16x16x32_bf16 v[28:31], a[52:55], a[32:35], v[28:31]
    buffer_load_dwordx4 v86, s[28:31], s82 offen offset:2048 lds
    v_mfma_f32_16x16x32_bf16 v[48:51], a[56:59], a[32:35], v[48:51]
    ds_read_b64_tr_b16 a[50:51], v85 offset:14848
    s_add_u32 s82, s82, 98304
    v_mfma_f32_16x16x32_bf16 v[68:71], a[32:35], a[60:63], v[68:71]
    ds_read_b128 a[4:7], v82 offset:17152
    s_cmp_ge_u32 s82, s86
    s_cselect_b32 s87, 1572864, 0
    v_mfma_f32_16x16x32_bf16 v[32:35], a[52:55], a[36:39], v[32:35]
    ds_read_b128 a[8:11], v82 offset:34048
    s_sub_u32 s82, s82, s87
    v_mfma_f32_16x16x32_bf16 v[52:55], a[56:59], a[36:39], v[52:55]
    ds_read_b128 a[12:15], v83 offset:256
    s_add_u32 m0, s81, 49152
    v_mfma_f32_16x16x32_bf16 v[72:75], a[36:39], a[60:63], v[72:75]
    ds_read_b128 a[16:19], v83 offset:17152
    s_waitcnt lgkmcnt(4)
    v_mfma_f32_16x16x32_bf16 v[16:19], a[40:43], v[232:235], v[16:19]
    s_waitcnt vmcnt(13)
    s_barrier
    v_mfma_f32_16x16x32_bf16 v[36:39], a[44:47], a[0:3], v[36:39]
    buffer_load_dwordx4 v86, s[28:31], s82 offen offset:0 lds
    v_mfma_f32_16x16x32_bf16 v[56:59], a[0:3], a[48:51], v[56:59]
    ds_read_b64_tr_b16 a[52:53], v85 offset:24576
    s_waitcnt lgkmcnt(3)
    v_mfma_f32_16x16x32_bf16 v[20:23], a[40:43], a[4:7], v[20:23]
    ds_read_b64_tr_b16 a[54:55], v85 offset:25088
    v_mfma_f32_16x16x32_bf16 v[40:43], a[44:47], a[4:7], v[40:43]
    ds_read_b128 a[20:23], v82 offset:320
    v_mfma_f32_16x16x32_bf16 v[60:63], a[4:7], a[48:51], v[60:63]
    buffer_load_dwordx4 v86, s[28:31], s82 offen offset:1024 lds
    v_mfma_f32_16x16x32_bf16 v[24:27], a[40:43], a[8:11], v[24:27]
    ds_read_b64_tr_b16 a[56:57], v85 offset:25600
    v_mfma_f32_16x16x32_bf16 v[44:47], a[44:47], a[8:11], v[44:47]
    ds_read_b64_tr_b16 a[58:59], v85 offset:26112
    v_mfma_f32_16x16x32_bf16 v[64:67], a[8:11], a[48:51], v[64:67]
    ds_read_b64_tr_b16 a[60:61], v85 offset:26624
    s_waitcnt lgkmcnt(6)
    v_mfma_f32_16x16x32_bf16 v[28:31], a[40:43], a[12:15], v[28:31]
    buffer_load_dwordx4 v86, s[28:31], s82 offen offset:2048 lds
    v_mfma_f32_16x16x32_bf16 v[48:51], a[44:47], a[12:15], v[48:51]
    ds_read_b64_tr_b16 a[62:63], v85 offset:27136
    s_add_u32 s82, s82, 98304
    v_mfma_f32_16x16x32_bf16 v[68:71], a[12:15], a[48:51], v[68:71]
    ds_read_b128 a[24:27], v82 offset:17216
    s_cmp_ge_u32 s82, s86
    s_cselect_b32 s87, 1572864, 0
    v_mfma_f32_16x16x32_bf16 v[32:35], a[40:43], a[16:19], v[32:35]
    ds_read_b128 a[28:31], v82 offset:34112
    s_sub_u32 s82, s82, s87
    v_mfma_f32_16x16x32_bf16 v[52:55], a[44:47], a[16:19], v[52:55]
    ds_read_b128 a[32:35], v83 offset:320
    s_add_u32 m0, s81, 61440
    v_mfma_f32_16x16x32_bf16 v[72:75], a[16:19], a[48:51], v[72:75]
    ds_read_b128 a[36:39], v83 offset:17216
    s_waitcnt lgkmcnt(4)
    v_mfma_f32_16x16x32_bf16 v[16:19], a[52:55], v[232:235], v[16:19]
    s_waitcnt vmcnt(13)
    s_barrier
    s_waitcnt vmcnt(9)
    s_mov_b32 s84, 0
L_spinhel_4:
    v_cmp_ne_u32 vcc, 1, v92
    s_add_u32 s84, s84, 1
    s_cbranch_vccz L_donehel_5
    buffer_load_dword v92, v91, s[60:63], 0 offen sc1
    s_cmp_ge_u32 s84, 400000
    s_waitcnt vmcnt(0)
    s_cbranch_scc0 L_spinhel_4
L_donehel_5:
    v_mfma_f32_16x16x32_bf16 v[36:39], a[56:59], a[20:23], v[36:39]
    buffer_load_dwordx4 v86, s[28:31], s82 offen offset:0 lds
    v_mfma_f32_16x16x32_bf16 v[56:59], a[20:23], a[60:63], v[56:59]
    ds_read_b64_tr_b16 a[40:41], v84 offset:0
    s_waitcnt lgkmcnt(3)
    v_mfma_f32_16x16x32_bf16 v[20:23], a[52:55], a[24:27], v[20:23]
    ds_read_b64_tr_b16 a[42:43], v84 offset:512
    v_mfma_f32_16x16x32_bf16 v[40:43], a[56:59], a[24:27], v[40:43]
    ds_read_b128 a[0:3], v82 offset:384
    v_mfma_f32_16x16x32_bf16 v[60:63], a[24:27], a[60:63], v[60:63]
    buffer_load_dwordx4 v86, s[28:31], s82 offen offset:1024 lds
    v_mfma_f32_16x16x32_bf16 v[24:27], a[52:55], a[28:31], v[24:27]
    ds_read_b64_tr_b16 a[44:45], v84 offset:1024
    v_mfma_f32_16x16x32_bf16 v[44:47], a[56:59], a[28:31], v[44:47]
    ds_read_b64_tr_b16 a[46:47], v84 offset:1536
    v_mfma_f32_16x16x32_bf16 v[64:67], a[28:31], a[60:63], v[64:67]
    ds_read_b64_tr_b16 a[48:49], v84 offset:2048
    s_waitcnt lgkmcnt(6)
    v_mfma_f32_16x16x32_bf16 v[28:31], a[52:55], a[32:35], v[28:31]
    buffer_load_dwordx4 v86, s[28:31], s82 offen offset:2048 lds
    v_mfma_f32_16x16x32_bf16 v[48:51], a[56:59], a[32:35], v[48:51]
    ds_read_b64_tr_b16 a[50:51], v84 offset:2560
    s_add_u32 s82, s82, 98304
    v_mfma_f32_16x16x32_bf16 v[68:71], a[32:35], a[60:63], v[68:71]
    ds_read_b128 a[4:7], v82 offset:17280
    s_cmp_ge_u32 s82, s86
    s_cselect_b32 s87, 1572864, 0
    v_mov_b32 v92, s9
    v_lshrrev_b32 v91, 2, v11
    s_cmp_eq_u32 s68, 0
    s_cselect_b64 exec, 1, 0
    buffer_store_dword v92, v91, s[48:51], s74 offen offset:768
    s_mov_b64 exec, -1
    v_mfma_f32_16x16x32_bf16 v[32:35], a[52:55], a[36:39], v[32:35]
    ds_read_b128 a[8:11], v82 offset:34176
    s_sub_u32 s82, s82, s87
    v_mfma_f32_16x16x32_bf16 v[52:55], a[56:59], a[36:39], v[52:55]
    ds_read_b128 a[12:15], v83 offset:384
    s_add_u32 m0, s81, 0
    v_mfma_f32_16x16x32_bf16 v[72:75], a[36:39], a[60:63], v[72:75]
    ds_read_b128 a[16:19], v83 offset:17280
    s_waitcnt lgkmcnt(4)
    v_mfma_f32_16x16x32_bf16 v[16:19], a[40:43], v[232:235], v[16:19]
    s_barrier
    v_mfma_f32_16x16x32_bf16 v[36:39], a[44:47], a[0:3], v[36:39]
    buffer_load_dwordx4 v86, s[28:31], s82 offen offset:0 lds
    v_mfma_f32_16x16x32_bf16 v[56:59], a[0:3], a[48:51], v[56:59]
    ds_read_b64_tr_b16 a[52:53], v84 offset:12288
    s_waitcnt lgkmcnt(3)
    v_mfma_f32_16x16x32_bf16 v[20:23], a[40:43], a[4:7], v[20:23]
    ds_read_b64_tr_b16 a[54:55], v84 offset:12800
    v_mfma_f32_16x16x32_bf16 v[40:43], a[44:47], a[4:7], v[40:43]
    ds_read_b128 a[20:23], v82 offset:448
    v_mfma_f32_16x16x32_bf16 v[60:63], a[4:7], a[48:51], v[60:63]
    buffer_load_dwordx4 v86, s[28:31], s82 offen offset:1024 lds
    v_mfma_f32_16x16x32_bf16 v[24:27], a[40:43], a[8:11], v[24:27]
    ds_read_b64_tr_b16 a[56:57], v84 offset:13312
    v_mfma_f32_16x16x32_bf16 v[44:47], a[44:47], a[8:11], v[44:47]
    ds_read_b64_tr_b16 a[58:59], v84 offset:13824
    v_mfma_f32_16x16x32_bf16 v[64:67], a[8:11], a[48:51], v[64:67]
    ds_read_b64_tr_b16 a[60:61], v84 offset:14336
    s_waitcnt lgkmcnt(6)
    v_mfma_f32_16x16x32_bf16 v[28:31], a[40:43], a[12:15], v[28:31]
    buffer_load_dwordx4 v86, s[28:31], s82 offen offset:2048 lds
    v_mfma_f32_16x16x32_bf16 v[48:51], a[44:47], a[12:15], v[48:51]
    ds_read_b64_tr_b16 a[62:63], v84 offset:14848
    s_add_u32 s82, s82, 98304
    v_mfma_f32_16x16x32_bf16 v[68:71], a[12:15], a[48:51], v[68:71]
    ds_read_b128 a[24:27], v82 offset:17344
    s_cmp_ge_u32 s82, s86
    s_cselect_b32 s87, 1572864, 0
    v_mfma_f32_16x16x32_bf16 v[32:35], a[40:43], a[16:19], v[32:35]
    ds_read_b128 a[28:31], v82 offset:34240
    s_sub_u32 s82, s82, s87
    v_mfma_f32_16x16x32_bf16 v[52:55], a[44:47], a[16:19], v[52:55]
    ds_read_b128 a[32:35], v83 offset:448
    s_add_u32 m0, s81, 12288
    s_lshr_b32 s76, s2, 3
    s_lshl_b32 s76, s76, 2
    s_add_u32 s76, s76, s68
    s_mul_i32 s76, s76, 4096
    v_lshlrev_b32 v10, 10, v0
    s_mov_b64 exec, 15
    buffer_load_dword v231, v10, s[32:35], s76 offen offset:384
    s_mov_b64 exec, -1
    v_mfma_f32_16x16x32_bf16 v[72:75], a[16:19], a[48:51], v[72:75]
    ds_read_b128 a[36:39], v83 offset:17344
    s_waitcnt lgkmcnt(4)
    v_mfma_f32_16x16x32_bf16 v[16:19], a[52:55], v[232:235], v[16:19]
    s_waitcnt vmcnt(14)
    s_barrier
    v_mfma_f32_16x16x32_bf16 v[36:39], a[56:59], a[20:23], v[36:39]
    buffer_load_dwordx4 v86, s[28:31], s82 offen offset:0 lds
    v_mfma_f32_16x16x32_bf16 v[56:59], a[20:23], a[60:63], v[56:59]
    ds_read_b64_tr_b16 a[40:41], v84 offset:24576
    s_waitcnt lgkmcnt(3)
    v_mfma_f32_16x16x32_bf16 v[20:23], a[52:55], a[24:27], v[20:23]
    ds_read_b64_tr_b16 a[42:43], v84 offset:25088
    v_mfma_f32_16x16x32_bf16 v[40:43], a[56:59], a[24:27], v[40:43]
    ds_read_b128 a[0:3], v82 offset:512
    v_mfma_f32_16x16x32_bf16 v[60:63], a[24:27], a[60:63], v[60:63]
    buffer_load_dwordx4 v86, s[28:31], s82 offen offset:1024 lds
    v_mfma_f32_16x16x32_bf16 v[24:27], a[52:55], a[28:31], v[24:27]
    ds_read_b64_tr_b16 a[44:45], v84 offset:25600
    v_mfma_f32_16x16x32_bf16 v[44:47], a[56:59], a[28:31], v[44:47]
    ds_read_b64_tr_b16 a[46:47], v84 offset:26112
    v_mfma_f32_16x16x32_bf16 v[64:67], a[28:31], a[60:63], v[64:67]
    ds_read_b64_tr_b16 a[48:49], v84 offset:26624
    s_waitcnt lgkmcnt(6)
    v_mfma_f32_16x16x32_bf16 v[28:31], a[52:55], a[32:35], v[28:31]
    buffer_load_dwordx4 v86, s[28:31], s82 offen offset:2048 lds
    v_mfma_f32_16x16x32_bf16 v[48:51], a[56:59], a[32:35], v[48:51]
    ds_read_b64_tr_b16 a[50:51], v84 offset:27136
    s_add_u32 s82, s82, 98304
    v_mfma_f32_16x16x32_bf16 v[68:71], a[32:35], a[60:63], v[68:71]
    ds_read_b128 a[4:7], v82 offset:17408
    s_cmp_ge_u32 s82, s86
    s_cselect_b32 s87, 1572864, 0
    v_mfma_f32_16x16x32_bf16 v[32:35], a[52:55], a[36:39], v[32:35]
    ds_read_b128 a[8:11], v82 offset:34304
    s_sub_u32 s82, s82, s87
    v_mfma_f32_16x16x32_bf16 v[52:55], a[56:59], a[36:39], v[52:55]
    ds_read_b128 a[12:15], v83 offset:512
    s_add_u32 m0, s81, 24576
    v_mfma_f32_16x16x32_bf16 v[72:75], a[36:39], a[60:63], v[72:75]
    ds_read_b128 a[16:19], v83 offset:17408
    s_waitcnt lgkmcnt(4)
    v_mfma_f32_16x16x32_bf16 v[16:19], a[40:43], v[232:235], v[16:19]
    s_waitcnt vmcnt(14)
    s_barrier
    v_mfma_f32_16x16x32_bf16 v[36:39], a[44:47], a[0:3], v[36:39]
    buffer_load_dwordx4 v86, s[28:31], s82 offen offset:0 lds
    v_mfma_f32_16x16x32_bf16 v[56:59], a[0:3], a[48:51], v[56:59]
    ds_read_b64_tr_b16 a[52:53], v85 offset:0
    s_waitcnt lgkmcnt(3)
    v_mfma_f32_16x16x32_bf16 v[20:23], a[40:43], a[4:7], v[20:23]
    ds_read_b64_tr_b16 a[54:55], v85 offset:512
    v_mfma_f32_16x16x32_bf16 v[40:43], a[44:47], a[4:7], v[40:43]
    ds_read_b128 a[20:23], v82 offset:576
    v_mfma_f32_16x16x32_bf16 v[60:63], a[4:7], a[48:51], v[60:63]
    buffer_load_dwordx4 v86, s[28:31], s82 offen offset:1024 lds
    v_mfma_f32_16x16x32_bf16 v[24:27], a[40:43], a[8:11], v[24:27]
    ds_read_b64_tr_b16 a[56:57], v85 offset:1024
    v_mfma_f32_16x16x32_bf16 v[44:47], a[44:47], a[8:11], v[44:47]
    ds_read_b64_tr_b16 a[58:59], v85 offset:1536
    v_mfma_f32_16x16x32_bf16 v[64:67], a[8:11], a[48:51], v[64:67]
    ds_read_b64_tr_b16 a[60:61], v85 offset:2048
    s_waitcnt lgkmcnt(6)
    v_mfma_f32_16x16x32_bf16 v[28:31], a[40:43], a[12:15], v[28:31]
    buffer_load_dwordx4 v86, s[28:31], s82 offen offset:2048 lds
    v_mfma_f32_16x16x32_bf16 v[48:51], a[44:47], a[12:15], v[48:51]
    ds_read_b64_tr_b16 a[62:63], v85 offset:2560
    s_add_u32 s82, s82, 98304
    v_mfma_f32_16x16x32_bf16 v[68:71], a[12:15], a[48:51], v[68:71]
    ds_read_b128 a[24:27], v82 offset:17472
    s_cmp_ge_u32 s82, s86
    s_cselect_b32 s87, 1572864, 0
    v_mfma_f32_16x16x32_bf16 v[32:35], a[40:43], a[16:19], v[32:35]
    ds_read_b128 a[28:31], v82 offset:34368
    s_sub_u32 s82, s82, s87
    v_mfma_f32_16x16x32_bf16 v[52:55], a[44:47], a[16:19], v[52:55]
    ds_read_b128 a[32:35], v83 offset:576
    s_add_u32 m0, s81, 36864
    v_mfma_f32_16x16x32_bf16 v[72:75], a[16:19], a[48:51], v[72:75]
    ds_read_b128 a[36:39], v83 offset:17472
    s_waitcnt lgkmcnt(4)
    v_mfma_f32_16x16x32_bf16 v[16:19], a[52:55], v[232:235], v[16:19]
    s_waitcnt vmcnt(14)
    s_barrier
    v_mfma_f32_16x16x32_bf16 v[36:39], a[56:59], a[20:23], v[36:39]
    buffer_load_dwordx4 v86, s[28:31], s82 offen offset:0 lds
    v_mfma_f32_16x16x32_bf16 v[56:59], a[20:23], a[60:63], v[56:59]
    ds_read_b64_tr_b16 a[40:41], v85 offset:12288
    s_waitcnt lgkmcnt(3)
    v_mfma_f32_16x16x32_bf16 v[20:23], a[52:55], a[24:27], v[20:23]
    ds_read_b64_tr_b16 a[42:43], v85 offset:12800
    v_mfma_f32_16x16x32_bf16 v[40:43], a[56:59], a[24:27], v[40:43]
    ds_read_b128 a[0:3], v82 offset:640
    v_mfma_f32_16x16x32_bf16 v[60:63], a[24:27], a[60:63], v[60:63]
    buffer_load_dwordx4 v86, s[28:31], s82 offen offset:1024 lds
    v_mfma_f32_16x16x32_bf16 v[24:27], a[52:55], a[28:31], v[24:27]
    ds_read_b64_tr_b16 a[44:45], v85 offset:13312
    v_mfma_f32_16x16x32_bf16 v[44:47], a[56:59], a[28:31], v[44:47]
    ds_read_b64_tr_b16 a[46:47], v85 offset:13824
    v_mfma_f32_16x16x32_bf16 v[64:67], a[28:31], a[60:63], v[64:67]
    ds_read_b64_tr_b16 a[48:49], v85 offset:14336
    s_waitcnt lgkmcnt(6)
    v_mfma_f32_16x16x32_bf16 v[28:31], a[52:55], a[32:35], v[28:31]
    buffer_load_dwordx4 v86, s[28:31], s82 offen offset:2048 lds
    v_mfma_f32_16x16x32_bf16 v[48:51], a[56:59], a[32:35], v[48:51]
    ds_read_b64_tr_b16 a[50:51], v85 offset:14848
    s_lshl_b32 s86, s68, 17
    s_lshl_b32 s76, s72, 7
    s_add_u32 s86, s86, s76
    s_lshl_b32 s87, s94, 14
    v_mfma_f32_16x16x32_bf16 v[68:71], a[32:35], a[60:63], v[68:71]
    ds_read_b128 a[4:7], v82 offset:17536
    v_mfma_f32_16x16x32_bf16 v[32:35], a[52:55], a[36:39], v[32:35]
    ds_read_b128 a[8:11], v82 offset:34432
    v_mfma_f32_16x16x32_bf16 v[52:55], a[56:59], a[36:39], v[52:55]
    ds_read_b128 a[12:15], v83 offset:640
    v_mfma_f32_16x16x32_bf16 v[72:75], a[36:39], a[60:63], v[72:75]
    ds_read_b128 a[16:19], v83 offset:17536
    s_add_u32 m0, s81, 49152
    s_add_u32 s82, s87, s86
    s_waitcnt lgkmcnt(4)
    v_mfma_f32_16x16x32_bf16 v[16:19], a[40:43], v[232:235], v[16:19]
    s_waitcnt vmcnt(14)
    s_barrier
    v_mfma_f32_16x16x32_bf16 v[36:39], a[44:47], a[0:3], v[36:39]
    buffer_load_dwordx4 v224, s[32:35], s82 offen lds
    v_mfma_f32_16x16x32_bf16 v[56:59], a[0:3], a[48:51], v[56:59]
    ds_read_b64_tr_b16 a[52:53], v85 offset:24576
    s_add_u32 m0, s81, 50176
    s_add_u32 s87, s87, 16384
    s_and_b32 s87, s87, 0x1ffff
    s_waitcnt lgkmcnt(3)
    v_mfma_f32_16x16x32_bf16 v[20:23], a[40:43], a[4:7], v[20:23]
    ds_read_b64_tr_b16 a[54:55], v85 offset:25088
    v_mfma_f32_16x16x32_bf16 v[40:43], a[44:47], a[4:7], v[40:43]
    ds_read_b128 a[20:23], v82 offset:704
    v_mfma_f32_16x16x32_bf16 v[60:63], a[4:7], a[48:51], v[60:63]
    buffer_load_dwordx4 v238, s[32:35], s82 offen lds
    v_mfma_f32_16x16x32_bf16 v[24:27], a[40:43], a[8:11], v[24:27]
    ds_read_b64_tr_b16 a[56:57], v85 offset:25600
    s_add_u32 m0, s81, 51200
    s_add_u32 s82, s87, s86
    v_mfma_f32_16x16x32_bf16 v[44:47], a[44:47], a[8:11], v[44:47]
    ds_read_b64_tr_b16 a[58:59], v85 offset:26112
    v_mfma_f32_16x16x32_bf16 v[64:67], a[8:11], a[48:51], v[64:67]
    ds_read_b64_tr_b16 a[60:61], v85 offset:26624
    s_waitcnt lgkmcnt(6)
    v_mfma_f32_16x16x32_bf16 v[28:31], a[40:43], a[12:15], v[28:31]
    buffer_load_dwordx4 v224, s[32:35], s82 offen lds
    v_mfma_f32_16x16x32_bf16 v[48:51], a[44:47], a[12:15], v[48:51]
    ds_read_b64_tr_b16 a[62:63], v85 offset:27136
    s_add_u32 m0, s81, 61440
    s_add_u32 s87, s87, 16384
    s_and_b32 s87, s87, 0x1ffff
    v_mfma_f32_16x16x32_bf16 v[68:71], a[12:15], a[48:51], v[68:71]
    ds_read_b128 a[24:27], v82 offset:17600
    v_mfma_f32_16x16x32_bf16 v[32:35], a[40:43], a[16:19], v[32:35]
    ds_read_b128 a[28:31], v82 offset:34496
    v_mfma_f32_16x16x32_bf16 v[52:55], a[44:47], a[16:19], v[52:55]
    ds_read_b128 a[32:35], v83 offset:704
    s_mul_i32 s76, s23, 1792
    s_mov_b64 exec, 16383
    buffer_load_dword v231, v239, s[40:43], s76 offen
    s_mov_b64 exec, -1
    v_mfma_f32_16x16x32_bf16 v[72:75], a[16:19], a[48:51], v[72:75]
    ds_read_b128 a[36:39], v83 offset:17600
    s_waitcnt lgkmcnt(4)
    v_mfma_f32_16x16x32_bf16 v[16:19], a[52:55], v[232:235], v[16:19]
    s_waitcnt vmcnt(14)
    s_barrier
    v_mfma_f32_16x16x32_bf16 v[36:39], a[56:59], a[20:23], v[36:39]
    buffer_load_dwordx4 v238, s[32:35], s82 offen lds
    v_mfma_f32_16x16x32_bf16 v[56:59], a[20:23], a[60:63], v[56:59]
    ds_read_b64_tr_b16 a[40:41], v84 offset:0
    s_add_u32 m0, s81, 62464
    s_add_u32 s82, s87, s86
    s_waitcnt lgkmcnt(3)
    v_mfma_f32_16x16x32_bf16 v[20:23], a[52:55], a[24:27], v[20:23]
    ds_read_b64_tr_b16 a[42:43], v84 offset:512
    v_mfma_f32_16x16x32_bf16 v[40:43], a[56:59], a[24:27], v[40:43]
    ds_read_b128 a[0:3], v82 offset:768
    v_mfma_f32_16x16x32_bf16 v[60:63], a[24:27], a[60:63], v[60:63]
    buffer_load_dwordx4 v224, s[32:35], s82 offen lds
    v_mfma_f32_16x16x32_bf16 v[24:27], a[52:55], a[28:31], v[24:27]
    ds_read_b64_tr_b16 a[44:45], v84 offset:1024
    s_add_u32 m0, s81, 63488
    s_add_u32 s87, s87, 16384
    s_and_b32 s87, s87, 0x1ffff
    v_mfma_f32_16x16x32_bf16 v[44:47], a[56:59], a[28:31], v[44:47]
    ds_read_b64_tr_b16 a[46:47], v84 offset:1536
    v_mfma_f32_16x16x32_bf16 v[64:67], a[28:31], a[60:63], v[64:67]
    ds_read_b64_tr_b16 a[48:49], v84 offset:2048
    s_waitcnt lgkmcnt(6)
    v_mfma_f32_16x16x32_bf16 v[28:31], a[52:55], a[32:35], v[28:31]
    buffer_load_dwordx4 v238, s[32:35], s82 offen lds
    v_mfma_f32_16x16x32_bf16 v[48:51], a[56:59], a[32:35], v[48:51]
    ds_read_b64_tr_b16 a[50:51], v84 offset:2560
    s_add_u32 m0, s81, 0
    s_add_u32 s82, s87, s86
    v_mfma_f32_16x16x32_bf16 v[68:71], a[32:35], a[60:63], v[68:71]
    ds_read_b128 a[4:7], v82 offset:17664
    v_mfma_f32_16x16x32_bf16 v[32:35], a[52:55], a[36:39], v[32:35]
    ds_read_b128 a[8:11], v82 offset:34560
    v_mfma_f32_16x16x32_bf16 v[52:55], a[56:59], a[36:39], v[52:55]
    ds_read_b128 a[12:15], v83 offset:768
    v_mfma_f32_16x16x32_bf16 v[72:75], a[36:39], a[60:63], v[72:75]
    ds_read_b128 a[16:19], v83 offset:17664
    s_waitcnt lgkmcnt(4)
    v_mfma_f32_16x16x32_bf16 v[16:19], a[40:43], v[232:235], v[16:19]
    s_waitcnt vmcnt(13)
    s_barrier
    v_mfma_f32_16x16x32_bf16 v[36:39], a[44:47], a[0:3], v[36:39]
    buffer_load_dwordx4 v224, s[32:35], s82 offen lds
    v_mfma_f32_16x16x32_bf16 v[56:59], a[0:3], a[48:51], v[56:59]
    ds_read_b64_tr_b16 a[52:53], v84 offset:12288
    s_add_u32 m0, s81, 1024
    s_add_u32 s87, s87, 16384
    s_and_b32 s87, s87, 0x1ffff
    s_waitcnt lgkmcnt(3)
    v_mfma_f32_16x16x32_bf16 v[20:23], a[40:43], a[4:7], v[20:23]
    ds_read_b64_tr_b16 a[54:55], v84 offset:12800
    v_mfma_f32_16x16x32_bf16 v[40:43], a[44:47], a[4:7], v[40:43]
    ds_read_b128 a[20:23], v82 offset:832
    v_mfma_f32_16x16x32_bf16 v[60:63], a[4:7], a[48:51], v[60:63]
    buffer_load_dwordx4 v238, s[32:35], s82 offen lds
    v_mfma_f32_16x16x32_bf16 v[24:27], a[40:43], a[8:11], v[24:27]
    ds_read_b64_tr_b16 a[56:57], v84 offset:13312
    s_add_u32 m0, s81, 2048
    s_add_u32 s82, s87, s86
    v_mfma_f32_16x16x32_bf16 v[44:47], a[44:47], a[8:11], v[44:47]
    ds_read_b64_tr_b16 a[58:59], v84 offset:13824
    v_mfma_f32_16x16x32_bf16 v[64:67], a[8:11], a[48:51], v[64:67]
    ds_read_b64_tr_b16 a[60:61], v84 offset:14336
    s_waitcnt lgkmcnt(6)
    v_mfma_f32_16x16x32_bf16 v[28:31], a[40:43], a[12:15], v[28:31]
    buffer_load_dwordx4 v224, s[32:35], s82 offen lds
    v_mfma_f32_16x16x32_bf16 v[48:51], a[44:47], a[12:15], v[48:51]
    ds_read_b64_tr_b16 a[62:63], v84 offset:14848
    s_add_u32 m0, s81, 12288
    s_add_u32 s87, s87, 16384
    s_and_b32 s87, s87, 0x1ffff
    v_mfma_f32_16x16x32_bf16 v[68:71], a[12:15], a[48:51], v[68:71]
    ds_read_b128 a[24:27], v82 offset:17728
    v_mfma_f32_16x16x32_bf16 v[32:35], a[40:43], a[16:19], v[32:35]
    ds_read_b128 a[28:31], v82 offset:34624
    v_mfma_f32_16x16x32_bf16 v[52:55], a[44:47], a[16:19], v[52:55]
    ds_read_b128 a[32:35], v83 offset:832
    v_mfma_f32_16x16x32_bf16 v[72:75], a[16:19], a[48:51], v[72:75]
    ds_read_b128 a[36:39], v83 offset:17728
    s_waitcnt lgkmcnt(4)
    v_mfma_f32_16x16x32_bf16 v[16:19], a[52:55], v[232:235], v[16:19]
    s_waitcnt vmcnt(13)
    s_barrier
    v_mfma_f32_16x16x32_bf16 v[36:39], a[56:59], a[20:23], v[36:39]
    buffer_load_dwordx4 v238, s[32:35], s82 offen lds
    v_mfma_f32_16x16x32_bf16 v[56:59], a[20:23], a[60:63], v[56:59]
    ds_read_b64_tr_b16 a[40:41], v84 offset:24576
    s_add_u32 m0, s81, 13312
    s_add_u32 s82, s87, s86
    s_waitcnt lgkmcnt(3)
    v_mfma_f32_16x16x32_bf16 v[20:23], a[52:55], a[24:27], v[20:23]
    ds_read_b64_tr_b16 a[42:43], v84 offset:25088
    v_mfma_f32_16x16x32_bf16 v[40:43], a[56:59], a[24:27], v[40:43]
    ds_read_b128 a[0:3], v82 offset:896
    v_mfma_f32_16x16x32_bf16 v[60:63], a[24:27], a[60:63], v[60:63]
    buffer_load_dwordx4 v224, s[32:35], s82 offen lds
    v_mfma_f32_16x16x32_bf16 v[24:27], a[52:55], a[28:31], v[24:27]
    ds_read_b64_tr_b16 a[44:45], v84 offset:25600
    s_add_u32 m0, s81, 14336
    s_add_u32 s87, s87, 16384
    s_and_b32 s87, s87, 0x1ffff
    v_mfma_f32_16x16x32_bf16 v[44:47], a[56:59], a[28:31], v[44:47]
    ds_read_b64_tr_b16 a[46:47], v84 offset:26112
    v_mfma_f32_16x16x32_bf16 v[64:67], a[28:31], a[60:63], v[64:67]
    ds_read_b64_tr_b16 a[48:49], v84 offset:26624
    s_waitcnt lgkmcnt(6)
    v_mfma_f32_16x16x32_bf16 v[28:31], a[52:55], a[32:35], v[28:31]
    buffer_load_dwordx4 v238, s[32:35], s82 offen lds
    v_mfma_f32_16x16x32_bf16 v[48:51], a[56:59], a[32:35], v[48:51]
    ds_read_b64_tr_b16 a[50:51], v84 offset:27136
    s_add_u32 m0, s81, 24576
    s_add_u32 s82, s87, s86
    v_mfma_f32_16x16x32_bf16 v[68:71], a[32:35], a[60:63], v[68:71]
    ds_read_b128 a[4:7], v82 offset:17792
    v_mfma_f32_16x16x32_bf16 v[32:35], a[52:55], a[36:39], v[32:35]
    ds_read_b128 a[8:11], v82 offset:34688
    v_mfma_f32_16x16x32_bf16 v[52:55], a[56:59], a[36:39], v[52:55]
    ds_read_b128 a[12:15], v83 offset:896
    buffer_load_dword v92, v88, s[48:51], s74 offen offset:768 sc1
    v_mfma_f32_16x16x32_bf16 v[72:75], a[36:39], a[60:63], v[72:75]
    ds_read_b128 a[16:19], v83 offset:17792
    s_waitcnt lgkmcnt(4)
    v_mfma_f32_16x16x32_bf16 v[16:19], a[40:43], v[232:235], v[16:19]
    s_waitcnt vmcnt(14)
    s_barrier
    v_mfma_f32_16x16x32_bf16 v[36:39], a[44:47], a[0:3], v[36:39]
    buffer_load_dwordx4 v224, s[32:35], s82 offen lds
    v_mfma_f32_16x16x32_bf16 v[56:59], a[0:3], a[48:51], v[56:59]
    ds_read_b64_tr_b16 a[52:53], v85 offset:0
    s_add_u32 m0, s81, 25600
    s_add_u32 s87, s87, 16384
    s_and_b32 s87, s87, 0x1ffff
    s_waitcnt lgkmcnt(3)
    v_mfma_f32_16x16x32_bf16 v[20:23], a[40:43], a[4:7], v[20:23]
    ds_read_b64_tr_b16 a[54:55], v85 offset:512
    v_mfma_f32_16x16x32_bf16 v[40:43], a[44:47], a[4:7], v[40:43]
    ds_read_b128 a[20:23], v82 offset:960
    v_mfma_f32_16x16x32_bf16 v[60:63], a[4:7], a[48:51], v[60:63]
    buffer_load_dwordx4 v238, s[32:35], s82 offen lds
    v_mfma_f32_16x16x32_bf16 v[24:27], a[40:43], a[8:11], v[24:27]
    ds_read_b64_tr_b16 a[56:57], v85 offset:1024
    s_add_u32 m0, s81, 26624
    s_add_u32 s82, s87, s86
    v_mfma_f32_16x16x32_bf16 v[44:47], a[44:47], a[8:11], v[44:47]
    ds_read_b64_tr_b16 a[58:59], v85 offset:1536
    v_mfma_f32_16x16x32_bf16 v[64:67], a[8:11], a[48:51], v[64:67]
    ds_read_b64_tr_b16 a[60:61], v85 offset:2048
    s_waitcnt lgkmcnt(6)
    v_mfma_f32_16x16x32_bf16 v[28:31], a[40:43], a[12:15], v[28:31]
    buffer_load_dwordx4 v224, s[32:35], s82 offen lds
    v_mfma_f32_16x16x32_bf16 v[48:51], a[44:47], a[12:15], v[48:51]
    ds_read_b64_tr_b16 a[62:63], v85 offset:2560
    s_add_u32 m0, s81, 36864
    s_add_u32 s87, s87, 16384
    s_and_b32 s87, s87, 0x1ffff
    v_mfma_f32_16x16x32_bf16 v[68:71], a[12:15], a[48:51], v[68:71]
    ds_read_b128 a[24:27], v82 offset:17856
    v_mfma_f32_16x16x32_bf16 v[32:35], a[40:43], a[16:19], v[32:35]
    ds_read_b128 a[28:31], v82 offset:34752
    v_mfma_f32_16x16x32_bf16 v[52:55], a[44:47], a[16:19], v[52:55]
    ds_read_b128 a[32:35], v83 offset:960
    v_mfma_f32_16x16x32_bf16 v[72:75], a[16:19], a[48:51], v[72:75]
    ds_read_b128 a[36:39], v83 offset:17856
    s_waitcnt lgkmcnt(4)
    v_mfma_f32_16x16x32_bf16 v[16:19], a[52:55], v[232:235], v[16:19]
    s_barrier
    v_mfma_f32_16x16x32_bf16 v[36:39], a[56:59], a[20:23], v[36:39]
    buffer_load_dwordx4 v238, s[32:35], s82 offen lds
    ds_read_b64 v[2:3], v90 offset:0
    ds_read_b64 v[4:5], v90 offset:16
    v_mfma_f32_16x16x32_bf16 v[56:59], a[20:23], a[60:63], v[56:59]
    ds_read_b64 v[6:7], v90 offset:32
    ds_read_b64 v[8:9], v90 offset:48
    s_waitcnt lgkmcnt(6)
    v_mfma_f32_16x16x32_bf16 v[20:23], a[52:55], a[24:27], v[20:23]
    ds_read2_b32 v[96:97], v88 offset0:0 offset1:80
    v_mfma_f32_16x16x32_bf16 v[40:43], a[56:59], a[24:27], v[40:43]
    ds_read2_b32 v[98:99], v88 offset0:16 offset1:96
    v_mfma_f32_16x16x32_bf16 v[60:63], a[24:27], a[60:63], v[60:63]
    ds_read2_b32 v[100:101], v88 offset0:32 offset1:112
    v_mfma_f32_16x16x32_bf16 v[24:27], a[52:55], a[28:31], v[24:27]
    ds_read2_b32 v[102:103], v88 offset0:48 offset1:128
    v_mfma_f32_16x16x32_bf16 v[44:47], a[56:59], a[28:31], v[44:47]
    ds_read2_b32 v[104:105], v88 offset0:64 offset1:144
    v_mfma_f32_16x16x32_bf16 v[64:67], a[28:31], a[60:63], v[64:67]
    ds_read_b128 v[108:111], v89 offset:0
    ds_read_b128 v[112:115], v89 offset:320
    s_waitcnt lgkmcnt(11)
    v_mfma_f32_16x16x32_bf16 v[28:31], a[52:55], a[32:35], v[28:31]
    ds_read_b128 v[116:119], v89 offset:64
    ds_read_b128 v[120:123], v89 offset:384
    v_mfma_f32_16x16x32_bf16 v[48:51], a[56:59], a[32:35], v[48:51]
    ds_read_b128 v[124:127], v89 offset:128
    ds_read_b128 v[128:131], v89 offset:448
    v_mfma_f32_16x16x32_bf16 v[68:71], a[32:35], a[60:63], v[68:71]
    ds_read_b128 v[132:135], v89 offset:192
    ds_read_b128 v[136:139], v89 offset:512
    v_mfma_f32_16x16x32_bf16 v[32:35], a[52:55], a[36:39], v[32:35]
    ds_read_b128 v[140:143], v89 offset:256
    ds_read_b128 v[144:147], v89 offset:576
    v_mfma_f32_16x16x32_bf16 v[52:55], a[56:59], a[36:39], v[52:55]
    v_mfma_f32_16x16x32_bf16 v[72:75], a[36:39], a[60:63], v[72:75]
L_kjoin_2:
    s_waitcnt lgkmcnt(0)
    v_mov_b32_dpp v152, v36 row_newbcast:0 row_mask:0xf bank_mask:0xf
    v_mov_b32_dpp v153, v37 row_newbcast:0 row_mask:0xf bank_mask:0xf
    v_mov_b32_dpp v154, v38 row_newbcast:0 row_mask:0xf bank_mask:0xf
    v_mov_b32_dpp v155, v39 row_newbcast:0 row_mask:0xf bank_mask:0xf
    v_mov_b32 v156, v56
    v_mov_b32 v157, v56
    s_mov_b32 s80, 1052289595
    s_barrier
    s_add_u32 m0, s3, 81920
    s_nop 0
    buffer_load_dwordx4 v211, s[36:39], s16 offen lds
    s_add_u32 m0, s3, 82944
    s_nop 0
    buffer_load_dwordx4 v14, s[36:39], s16 offen lds
    s_add_u32 m0, s3, 90112
    s_nop 0
    buffer_load_dwordx4 v211, s[36:39], s17 offen lds
    v_permlane16_swap_b32 v156, v157
    v_mov_b32 v157, v156
    v_pk_fma_f32 v[36:37], v[152:153], v[96:97], v[36:37] op_sel_hi:[1,0,1]
    v_pk_fma_f32 v[38:39], v[154:155], v[96:97], v[38:39] op_sel_hi:[1,0,1]
    v_permlane32_swap_b32 v156, v157
    v_pk_mul_f32 v[36:37], v[36:37], v[96:97] op_sel:[0,1] op_sel_hi:[1,1]
    v_pk_mul_f32 v[38:39], v[38:39], v[96:97] op_sel:[0,1] op_sel_hi:[1,1]
    v_cvt_pk_bf16_f32 v36, v36, v37
    v_cvt_pk_bf16_f32 v37, v38, v39
    s_add_u32 m0, s3, 91136
    s_nop 0
    buffer_load_dwordx4 v14, s[36:39], s17 offen lds
    v_pk_fma_f32 v[40:41], v[152:153], v[98:99], v[40:41] op_sel_hi:[1,0,1]
    v_pk_fma_f32 v[42:43], v[154:155], v[98:99], v[42:43] op_sel_hi:[1,0,1]
    v_pk_fma_f32 v[20:21], v[16:17], v[98:99], v[20:21] op_sel_hi:[1,0,1]
    v_pk_fma_f32 v[22:23], v[18:19], v[98:99], v[22:23] op_sel_hi:[1,0,1]
    v_pk_mul_f32 v[40:41], v[40:41], v[98:99] op_sel:[0,1] op_sel_hi:[1,1]
    v_pk_mul_f32 v[42:43], v[42:43], v[98:99] op_sel:[0,1] op_sel_hi:[1,1]
    v_mul_f32 v168, s80, v99
    v_cvt_pk_bf16_f32 v20, v20, v21
    v_cvt_pk_bf16_f32 v21, v22, v23
    v_cvt_pk_bf16_f32 v40, v40, v41
    v_cvt_pk_bf16_f32 v41, v42, v43
    s_add_u32 m0, s3, 98304
    s_nop 0
    buffer_load_dwordx4 v211, s[36:39], s18 offen lds
    v_pk_fma_f32 v[44:45], v[152:153], v[100:101], v[44:45] op_sel_hi:[1,0,1]
    v_pk_fma_f32 v[46:47], v[154:155], v[100:101], v[46:47] op_sel_hi:[1,0,1]
    v_pk_fma_f32 v[24:25], v[16:17], v[100:101], v[24:25] op_sel_hi:[1,0,1]
    v_pk_fma_f32 v[26:27], v[18:19], v[100:101], v[26:27] op_sel_hi:[1,0,1]
    v_pk_mul_f32 v[44:45], v[44:45], v[100:101] op_sel:[0,1] op_sel_hi:[1,1]
    v_pk_mul_f32 v[46:47], v[46:47], v[100:101] op_sel:[0,1] op_sel_hi:[1,1]
    v_mul_f32 v169, s80, v101
    v_cvt_pk_bf16_f32 v24, v24, v25
    v_cvt_pk_bf16_f32 v25, v26, v27
    v_cvt_pk_bf16_f32 v44, v44, v45
    v_cvt_pk_bf16_f32 v45, v46, v47
    s_add_u32 m0, s3, 99328
    s_nop 0
    buffer_load_dwordx4 v14, s[36:39], s18 offen lds
    v_pk_fma_f32 v[48:49], v[152:153], v[102:103], v[48:49] op_sel_hi:[1,0,1]
    v_pk_fma_f32 v[50:51], v[154:155], v[102:103], v[50:51] op_sel_hi:[1,0,1]
    v_pk_fma_f32 v[28:29], v[16:17], v[102:103], v[28:29] op_sel_hi:[1,0,1]
    v_pk_fma_f32 v[30:31], v[18:19], v[102:103], v[30:31] op_sel_hi:[1,0,1]
    v_pk_mul_f32 v[48:49], v[48:49], v[102:103] op_sel:[0,1] op_sel_hi:[1,1]
    v_pk_mul_f32 v[50:51], v[50:51], v[102:103] op_sel:[0,1] op_sel_hi:[1,1]
    v_mul_f32 v170, s80, v103
    v_cvt_pk_bf16_f32 v28, v28, v29
    v_cvt_pk_bf16_f32 v29, v30, v31
    v_cvt_pk_bf16_f32 v48, v48, v49
    v_cvt_pk_bf16_f32 v49, v50, v51
    s_add_u32 m0, s3, 106496
    s_nop 0
    buffer_load_dwordx4 v211, s[36:39], s21 offen lds
    v_pk_fma_f32 v[52:53], v[152:153], v[104:105], v[52:53] op_sel_hi:[1,0,1]
    v_pk_fma_f32 v[54:55], v[154:155], v[104:105], v[54:55] op_sel_hi:[1,0,1]
    v_pk_fma_f32 v[32:33], v[16:17], v[104:105], v[32:33] op_sel_hi:[1,0,1]
    v_pk_fma_f32 v[34:35], v[18:19], v[104:105], v[34:35] op_sel_hi:[1,0,1]
    v_pk_mul_f32 v[52:53], v[52:53], v[104:105] op_sel:[0,1] op_sel_hi:[1,1]
    v_pk_mul_f32 v[54:55], v[54:55], v[104:105] op_sel:[0,1] op_sel_hi:[1,1]
    v_mul_f32 v171, s80, v105
    v_cvt_pk_bf16_f32 v32, v32, v33
    v_cvt_pk_bf16_f32 v33, v34, v35
    v_cvt_pk_bf16_f32 v52, v52, v53
    v_cvt_pk_bf16_f32 v53, v54, v55
    s_add_u32 m0, s3, 107520
    s_nop 0
    buffer_load_dwordx4 v14, s[36:39], s21 offen lds
    v_mfma_f32_16x16x16_bf16 v[176:179], v[36:37], v[20:21], v[248:251]
    v_mfma_f32_16x16x16_bf16 v[180:183], v[40:41], v[20:21], v[244:247]
    v_mfma_f32_16x16x16_bf16 v[184:187], v[40:41], v[24:25], v[240:243]
    v_mfma_f32_16x16x16_bf16 v[188:191], v[44:45], v[24:25], v[244:247]
    v_mfma_f32_16x16x16_bf16 v[192:195], v[44:45], v[28:29], v[240:243]
    v_mfma_f32_16x16x16_bf16 v[196:199], v[48:49], v[28:29], v[244:247]
    v_mfma_f32_16x16x16_bf16 v[200:203], v[48:49], v[32:33], v[240:243]
    v_mfma_f32_16x16x16_bf16 v[204:207], v[52:53], v[32:33], v[244:247]
    s_waitcnt vmcnt(12)
    v_cmp_ne_u32 vcc, s9, v92
    s_nop 0
    s_cbranch_vccnz L_gspin_9
L_gback_10:
    v_pk_fma_f32 v[56:57], v[108:109], v[156:157], v[56:57] op_sel_hi:[1,0,1]
    v_pk_fma_f32 v[58:59], v[110:111], v[156:157], v[58:59] op_sel_hi:[1,0,1]
    v_pk_mul_f32 v[56:57], v[56:57], v[112:113]
    v_pk_mul_f32 v[58:59], v[58:59], v[114:115]
    v_cvt_pk_bf16_f32 v158, v56, v57
    v_cvt_pk_bf16_f32 v159, v58, v59
    v_pk_fma_f32 v[60:61], v[116:117], v[156:157], v[60:61] op_sel_hi:[1,0,1]
    v_pk_fma_f32 v[62:63], v[118:119], v[156:157], v[62:63] op_sel_hi:[1,0,1]
    v_pk_mul_f32 v[60:61], v[60:61], v[120:121]
    v_pk_mul_f32 v[62:63], v[62:63], v[122:123]
    v_cvt_pk_bf16_f32 v160, v60, v61
    v_cvt_pk_bf16_f32 v161, v62, v63
    v_pk_fma_f32 v[64:65], v[124:125], v[156:157], v[64:65] op_sel_hi:[1,0,1]
    v_pk_fma_f32 v[66:67], v[126:127], v[156:157], v[66:67] op_sel_hi:[1,0,1]
    v_pk_mul_f32 v[64:65], v[64:65], v[128:129]
    v_pk_mul_f32 v[66:67], v[66:67], v[130:131]
    v_cvt_pk_bf16_f32 v162, v64, v65
    v_cvt_pk_bf16_f32 v163, v66, v67
    v_pk_fma_f32 v[68:69], v[132:133], v[156:157], v[68:69] op_sel_hi:[1,0,1]
    v_pk_fma_f32 v[70:71], v[134:135], v[156:157], v[70:71] op_sel_hi:[1,0,1]
    v_pk_mul_f32 v[68:69], v[68:69], v[136:137]
    v_pk_mul_f32 v[70:71], v[70:71], v[138:139]
    v_cvt_pk_bf16_f32 v164, v68, v69
    v_cvt_pk_bf16_f32 v165, v70, v71
    v_pk_fma_f32 v[72:73], v[140:141], v[156:157], v[72:73] op_sel_hi:[1,0,1]
    v_pk_fma_f32 v[74:75], v[142:143], v[156:157], v[74:75] op_sel_hi:[1,0,1]
    v_pk_mul_f32 v[72:73], v[72:73], v[144:145]
    v_pk_mul_f32 v[74:75], v[74:75], v[146:147]
    v_cvt_pk_bf16_f32 v166, v72, v73
    v_cvt_pk_bf16_f32 v167, v74, v75
    v_max3_f32 v108, v176, v177, v180
    v_max3_f32 v109, v178, v179, v182
    v_max3_f32 v110, v184, v185, v188
    v_max3_f32 v111, v186, v187, v190
    v_max3_f32 v112, v192, v193, v196
    v_max3_f32 v113, v194, v195, v198
    v_max3_f32 v114, v200, v201, v204
    v_max3_f32 v115, v202, v203, v206
    v_max_f32 v108, v108, v181
    v_max_f32 v109, v109, v183
    v_max_f32 v110, v110, v189
    v_max_f32 v111, v111, v191
    v_max_f32 v112, v112, v197
    v_max_f32 v113, v113, v199
    v_max_f32 v114, v114, v205
    v_max_f32 v115, v115, v207
    v_max_f32 v116, v108, v109
    v_max_f32 v117, v110, v111
    v_max_f32 v118, v112, v113
    v_max_f32 v119, v114, v115
    s_nop 0
    v_permlane32_swap_b32 v116, v118
    v_permlane32_swap_b32 v117, v119
    v_max_f32 v116, v116, v118
    v_max_f32 v117, v117, v119
    s_nop 1
    v_permlane16_swap_b32 v116, v117
    v_max_f32 v116, v116, v117
    v_mov_b32 v117, v116
    s_nop 1
    v_permlane16_swap_b32 v116, v117
    v_mov_b32 v118, v116
    v_mov_b32 v119, v117
    s_nop 0
    v_permlane32_swap_b32 v116, v118
    v_permlane32_swap_b32 v117, v119
    v_mul_f32 v116, v116, v168
    v_mul_f32 v117, v117, v169
    v_mul_f32 v118, v118, v170
    v_mul_f32 v119, v119, v171
    v_fma_f32 v108, v108, v168, -v116
    v_fma_f32 v109, v109, v168, -v116
    v_fma_f32 v110, v110, v169, -v117
    v_fma_f32 v111, v111, v169, -v117
    v_fma_f32 v112, v112, v170, -v118
    v_fma_f32 v113, v113, v170, -v118
    v_fma_f32 v114, v114, v171, -v119
    v_fma_f32 v115, v115, v171, -v119
    v_exp_f32 v108, v108
    v_exp_f32 v109, v109
    v_exp_f32 v110, v110
    v_exp_f32 v111, v111
    v_exp_f32 v112, v112
    v_exp_f32 v113, v113
    v_exp_f32 v114, v114
    v_exp_f32 v115, v115
    v_cvt_pk_bf16_f32 v108, v108, v108
    v_cvt_pk_bf16_f32 v109, v109, v109
    v_cvt_pk_bf16_f32 v110, v110, v110
    v_cvt_pk_bf16_f32 v111, v111, v111
    v_cvt_pk_bf16_f32 v112, v112, v112
    v_cvt_pk_bf16_f32 v113, v113, v113
    v_cvt_pk_bf16_f32 v114, v114, v114
    v_cvt_pk_bf16_f32 v115, v115, v115
    v_and_b32 v124, v108, v254
    v_and_b32 v126, v108, v252
    v_and_b32 v125, v109, v255
    v_and_b32 v127, v109, v253
    v_and_b32 v128, v110, v254
    v_and_b32 v130, v110, v252
    v_and_b32 v129, v111, v255
    v_and_b32 v131, v111, v253
    v_mfma_f32_16x16x32_bf16 v[192:195], v[232:235], v[124:127], 0
    v_and_b32 v132, v112, v254
    v_and_b32 v134, v112, v252
    v_and_b32 v133, v113, v255
    v_and_b32 v135, v113, v253
    v_mfma_f32_16x16x32_bf16 v[196:199], v[232:235], v[128:131], 0
    v_and_b32 v136, v114, v254
    v_and_b32 v138, v114, v252
    v_and_b32 v137, v115, v255
    v_and_b32 v139, v115, v253
    v_mfma_f32_16x16x32_bf16 v[200:203], v[232:235], v[132:135], 0
    v_mfma_f32_16x16x32_bf16 v[176:179], v[158:161], v[124:127], 0
    v_mfma_f32_16x16x32_bf16 v[204:207], v[232:235], v[136:139], 0
    v_mfma_f32_16x16x32_bf16 v[180:183], v[160:163], v[128:131], 0
    v_mfma_f32_16x16x32_bf16 v[184:187], v[162:165], v[132:135], 0
    v_mfma_f32_16x16x32_bf16 v[188:191], v[164:167], v[136:139], 0
    s_add_u32 s78, s6, 32768
    v_rcp_f32 v192, v192
    v_rcp_f32 v196, v196
    v_rcp_f32 v200, v200
    s_nop 0
    v_rcp_f32 v204, v204
    v_pk_mul_f32 v[176:177], v[176:177], v[192:193] op_sel_hi:[1,0]
    v_pk_mul_f32 v[178:179], v[178:179], v[192:193] op_sel_hi:[1,0]
    v_pk_mul_f32 v[180:181], v[180:181], v[196:197] op_sel_hi:[1,0]
    v_pk_mul_f32 v[182:183], v[182:183], v[196:197] op_sel_hi:[1,0]
    v_cvt_pk_bf16_f32 v96, v176, v177
    v_cvt_pk_bf16_f32 v97, v178, v179
    v_cvt_pk_bf16_f32 v98, v180, v181
    v_cvt_pk_bf16_f32 v99, v182, v183
    s_nop 0
    v_permlane16_swap_b32 v96, v98
    v_permlane16_swap_b32 v97, v99
    buffer_store_dwordx4 v[96:99], v1, s[48:51], s6 offen  sc1
    v_pk_mul_f32 v[184:185], v[184:185], v[200:201] op_sel_hi:[1,0]
    v_pk_mul_f32 v[186:187], v[186:187], v[200:201] op_sel_hi:[1,0]
    v_pk_mul_f32 v[188:189], v[188:189], v[204:205] op_sel_hi:[1,0]
    v_pk_mul_f32 v[190:191], v[190:191], v[204:205] op_sel_hi:[1,0]
    v_cvt_pk_bf16_f32 v100, v184, v185
    v_cvt_pk_bf16_f32 v101, v186, v187
    v_cvt_pk_bf16_f32 v102, v188, v189
    v_cvt_pk_bf16_f32 v103, v190, v191
    s_nop 0
    v_permlane16_swap_b32 v100, v102
    v_permlane16_swap_b32 v101, v103
    buffer_store_dwordx4 v[100:103], v1, s[48:51], s78 offen  sc1
    s_add_u32 m0, s3, 114688
    s_nop 0
    buffer_load_dwordx4 v211, s[36:39], s22 offen lds
    s_add_u32 m0, s3, 115712
    s_nop 0
    buffer_load_dwordx4 v14, s[36:39], s22 offen lds
    s_add_u32 m0, s3, 122880
    s_nop 0
    buffer_load_dwordx4 v211, s[36:39], s64 offen lds
    s_add_u32 m0, s3, 123904
    s_nop 0
    buffer_load_dwordx4 v14, s[36:39], s64 offen lds
    s_waitcnt vmcnt(14)
    ds_read_b64_tr_b16 a[0:1], v226 offset:49152
    ds_read_b64_tr_b16 a[4:5], v227 offset:49152
    ds_read_b64_tr_b16 a[2:3], v226 offset:50176
    ds_read_b64_tr_b16 a[6:7], v227 offset:50176
    ds_read_b64_tr_b16 a[8:9], v226 offset:51200
    ds_read_b64_tr_b16 a[12:13], v227 offset:51200
    ds_read_b64_tr_b16 a[10:11], v226 offset:61440
    ds_read_b64_tr_b16 a[14:15], v227 offset:61440
    ds_read_b64_tr_b16 a[16:17], v226 offset:62464
    ds_read_b64_tr_b16 a[20:21], v227 offset:62464
    ds_read_b64_tr_b16 a[18:19], v226 offset:63488
    ds_read_b64_tr_b16 a[22:23], v227 offset:63488
    ds_read_b64_tr_b16 a[24:25], v226 offset:0
    ds_read_b64_tr_b16 a[28:29], v227 offset:0
    ds_read_b64_tr_b16 a[26:27], v226 offset:1024
    ds_read_b64_tr_b16 a[30:31], v227 offset:1024
    ds_read_b64_tr_b16 a[32:33], v226 offset:2048
    ds_read_b64_tr_b16 a[36:37], v227 offset:2048
    ds_read_b64_tr_b16 a[34:35], v226 offset:12288
    ds_read_b64_tr_b16 a[38:39], v227 offset:12288
    ds_read_b64_tr_b16 a[40:41], v226 offset:13312
    ds_read_b64_tr_b16 a[44:45], v227 offset:13312
    ds_read_b64_tr_b16 a[42:43], v226 offset:14336
    ds_read_b64_tr_b16 a[46:47], v227 offset:14336
    ds_read_b64_tr_b16 a[48:49], v226 offset:24576
    ds_read_b64_tr_b16 a[52:53], v227 offset:24576
    ds_read_b64_tr_b16 a[50:51], v226 offset:25600
    ds_read_b64_tr_b16 a[54:55], v227 offset:25600
    ds_read_b64_tr_b16 a[56:57], v226 offset:26624
    ds_read_b64_tr_b16 a[60:61], v227 offset:26624
    ds_read_b64_tr_b16 a[58:59], v226 offset:36864
    ds_read_b64_tr_b16 a[62:63], v227 offset:36864
    s_waitcnt vmcnt(4)
    v_mov_b32 v12, 1
    s_mov_b64 exec, 1
    buffer_store_dword v12, v11, s[52:55], s74 offen offset:0
    buffer_store_dword v12, v11, s[56:59], s74 offen offset:0 sc1
    s_mov_b64 exec, -1
    buffer_load_dword v12, v225, s[48:51], s74 offen offset:0 sc1
    v_readfirstlane_b32 s75, v230
    v_bfe_u32 v10, v0, 1, 3
    v_lshlrev_b32 v10, 4, v10
    v_and_b32 v95, 1, v0
    v_lshl_add_u32 v10, v95, 2, v10
    s_lshl_b32 s76, s12, 7
    s_and_b32 s77, s68, 1
    s_lshl_b32 s77, s77, 3
    s_add_u32 s76, s76, s77
    v_add_u32 v222, s76, v10
    v_bfe_u32 v10, v0, 1, 4
    v_min_u32 v10, 13, v10
    v_lshlrev_b32 v10, 4, v10
    v_and_b32 v95, 1, v0
    v_lshl_add_u32 v10, v95, 2, v10
    s_and_b32 s76, s70, 8
    v_add_u32 v223, s76, v10
    s_lshl_b32 s101, s68, 14
    s_and_b32 s76, s72, 7
    s_lshl_b32 s76, s76, 7
    s_add_u32 s101, s101, s76
    s_mul_i32 s76, s94, 0
    s_lshr_b32 s76, s76, 2
    s_lshl_b32 s0, s76, 17
    s_add_u32 s0, s0, s101
    v_add_u32 v236, 131072, v208
    v_add_u32 v237, 131072, v209
    s_lshl_b32 s77, s71, 6
    s_lshl_b32 s78, s68, 3
    s_add_u32 s77, s77, s78
    s_lshl_b32 s77, s77, 10
    s_lshl_b32 s78, s12, 15
    s_add_u32 s11, s77, s78
    s_xor_b32 s10, s11, 32768
    s_lshl_b32 s87, s94, 10
    s_xor_b32 s76, s68, 0
    s_lshl_b32 s76, s76, 12
    v_add_u32 v128, s76, v1
    s_xor_b32 s76, s68, 1
    s_lshl_b32 s76, s76, 12
    v_add_u32 v129, s76, v1
    s_xor_b32 s76, s68, 2
    s_lshl_b32 s76, s76, 12
    v_add_u32 v130, s76, v1
    s_xor_b32 s76, s68, 3
    s_lshl_b32 s76, s76, 12
    v_add_u32 v131, s76, v1
    v_lshlrev_b32 v132, 16, v2
    v_and_b32 v133, 0xffff0000, v2
    v_lshlrev_b32 v134, 16, v3
    v_and_b32 v135, 0xffff0000, v3
    v_lshlrev_b32 v136, 16, v4
    v_and_b32 v137, 0xffff0000, v4
    v_lshlrev_b32 v138, 16, v5
    v_and_b32 v139, 0xffff0000, v5
    v_lshlrev_b32 v140, 16, v6
    v_and_b32 v141, 0xffff0000, v6
    v_lshlrev_b32 v142, 16, v7
    v_and_b32 v143, 0xffff0000, v7
    v_lshlrev_b32 v144, 16, v8
    v_and_b32 v145, 0xffff0000, v8
    v_lshlrev_b32 v146, 16, v9
    v_and_b32 v147, 0xffff0000, v9
    v_and_b32 v148, 15, v0
    v_lshlrev_b32 v148, 4, v148
    v_lshrrev_b32 v10, 4, v0
    v_lshl_add_u32 v148, v10, 2, v148
    s_lshl_b32 s76, s71, 1
    s_add_u32 s76, s76, s12
    s_lshl_b32 s76, s76, 12
    s_add_u32 s13, s76, 11534336
    s_lshl_b32 s79, s72, 1
    s_and_b32 s76, s68, 1
    s_add_u32 s79, s79, s76
    s_lshl_b32 s79, s79, 8
    s_add_u32 s79, s79, s13
    s_mov_b64 exec, 0
    s_branch L_pad_0
L_walk_1:
    s_mov_b64 exec, -1
    s_waitcnt vmcnt(0)
    s_mov_b32 s84, 0
L_spino_12:
    v_cmp_gt_u32 vcc, 1, v12
    s_add_u32 s84, s84, 1
    s_cbranch_vccz L_doneo_13
    buffer_load_dword v12, v225, s[48:51], s74 offen offset:0 sc1
    s_cmp_ge_u32 s84, 400000
    s_waitcnt vmcnt(0)
    s_cbranch_scc0 L_spino_12
L_doneo_13:
    s_add_u32 s78, s87, s10
    buffer_load_dwordx4 a[64:67], v1, s[48:51], s78 offen sc1
    s_add_u32 s87, s87, 1024
    s_and_b32 s87, s87, 0x1fff
    s_add_u32 s78, s87, s10
    buffer_load_dwordx4 a[68:71], v1, s[48:51], s78 offen sc1
    s_add_u32 s87, s87, 1024
    s_and_b32 s87, s87, 0x1fff
    s_add_u32 s78, s87, s10
    buffer_load_dwordx4 a[72:75], v1, s[48:51], s78 offen sc1
    s_add_u32 s87, s87, 1024
    s_and_b32 s87, s87, 0x1fff
    s_add_u32 s78, s87, s10
    buffer_load_dwordx4 a[76:79], v1, s[48:51], s78 offen sc1
    s_add_u32 s87, s87, 1024
    s_and_b32 s87, s87, 0x1fff
    s_add_u32 s78, s87, s10
    buffer_load_dwordx4 a[80:83], v1, s[48:51], s78 offen sc1
    s_add_u32 s87, s87, 1024
    s_and_b32 s87, s87, 0x1fff
    s_add_u32 s78, s87, s10
    buffer_load_dwordx4 a[84:87], v1, s[48:51], s78 offen sc1
    s_add_u32 s87, s87, 1024
    s_and_b32 s87, s87, 0x1fff
    s_add_u32 s78, s87, s10
    buffer_load_dwordx4 a[88:91], v1, s[48:51], s78 offen sc1
    s_add_u32 s87, s87, 1024
    s_and_b32 s87, s87, 0x1fff
    s_add_u32 s78, s87, s10
    buffer_load_dwordx4 a[92:95], v1, s[48:51], s78 offen sc1
    s_add_u32 s87, s87, 1024
    s_and_b32 s87, s87, 0x1fff
    s_add_u32 s78, s87, s11
    buffer_load_dwordx4 a[96:99], v1, s[48:51], s78 offen sc1
    s_add_u32 s87, s87, 1024
L_pad_0:
    s_cbranch_execz L_pad_1
    s_and_b32 s87, s87, 0x1fff
    s_add_u32 s78, s87, s11
    buffer_load_dwordx4 a[100:103], v1, s[48:51], s78 offen sc1
    s_add_u32 s87, s87, 1024
    s_and_b32 s87, s87, 0x1fff
    s_waitcnt lgkmcnt(0)
    s_barrier
    s_waitcnt vmcnt(9)
    v_mfma_f32_32x32x16_bf16 v[48:63], a[0:3], a[64:67], 0
    s_add_u32 s78, s87, s11
    buffer_load_dwordx4 a[104:107], v1, s[48:51], s78 offen sc1
    s_add_u32 s87, s87, 1024
    s_and_b32 s87, s87, 0x1fff
    v_mfma_f32_32x32x16_bf16 v[64:79], a[4:7], a[64:67], 0
    s_waitcnt vmcnt(9)
    v_mfma_f32_32x32x16_bf16 v[48:63], a[8:11], a[68:71], v[48:63]
    s_add_u32 s78, s87, s11
    buffer_load_dwordx4 a[108:111], v1, s[48:51], s78 offen sc1
    s_add_u32 s87, s87, 1024
    s_and_b32 s87, s87, 0x1fff
    v_mfma_f32_32x32x16_bf16 v[64:79], a[12:15], a[68:71], v[64:79]
    s_waitcnt vmcnt(9)
    v_mfma_f32_32x32x16_bf16 v[48:63], a[16:19], a[72:75], v[48:63]
    s_add_u32 s78, s87, s11
    buffer_load_dwordx4 a[112:115], v1, s[48:51], s78 offen sc1
    s_add_u32 s87, s87, 1024
    s_and_b32 s87, s87, 0x1fff
    v_mfma_f32_32x32x16_bf16 v[64:79], a[20:23], a[72:75], v[64:79]
    s_waitcnt vmcnt(9)
    v_mfma_f32_32x32x16_bf16 v[48:63], a[24:27], a[76:79], v[48:63]
    s_add_u32 s78, s87, s11
    buffer_load_dwordx4 a[116:119], v1, s[48:51], s78 offen sc1
    s_add_u32 s87, s87, 1024
    s_and_b32 s87, s87, 0x1fff
    v_mfma_f32_32x32x16_bf16 v[64:79], a[28:31], a[76:79], v[64:79]
    s_waitcnt vmcnt(9)
    v_mfma_f32_32x32x16_bf16 v[48:63], a[32:35], a[80:83], v[48:63]
    s_add_u32 s78, s87, s11
    buffer_load_dwordx4 a[120:123], v1, s[48:51], s78 offen sc1
    s_add_u32 s87, s87, 1024
    s_and_b32 s87, s87, 0x1fff
    v_mfma_f32_32x32x16_bf16 v[64:79], a[36:39], a[80:83], v[64:79]
    s_waitcnt vmcnt(9)
    v_mfma_f32_32x32x16_bf16 v[48:63], a[40:43], a[84:87], v[48:63]
    s_add_u32 s78, s87, s11
    buffer_load_dwordx4 a[124:127], v1, s[48:51], s78 offen sc1
    s_add_u32 s87, s87, 1024
    s_and_b32 s87, s87, 0x1fff
    v_mfma_f32_32x32x16_bf16 v[64:79], a[44:47], a[84:87], v[64:79]
    s_waitcnt vmcnt(9)
    v_mfma_f32_32x32x16_bf16 v[48:63], a[48:51], a[88:91], v[48:63]
    s_add_u32 m0, s3, 131072
    s_nop 0
    buffer_load_dwordx4 v211, s[36:39], s65 offen lds
    v_mfma_f32_32x32x16_bf16 v[64:79], a[52:55], a[88:91], v[64:79]
    s_add_u32 m0, s3, 132096
    s_nop 0
    buffer_load_dwordx4 v14, s[36:39], s65 offen lds
    s_waitcnt vmcnt(10)
    v_mfma_f32_32x32x16_bf16 v[48:63], a[56:59], a[92:95], v[48:63]
    s_add_u32 m0, s3, 139264
    s_nop 0
    buffer_load_dwordx4 v211, s[36:39], s66 offen lds
    v_mfma_f32_32x32x16_bf16 v[64:79], a[60:63], a[92:95], v[64:79]
    s_add_u32 m0, s3, 140288
    s_nop 0
    buffer_load_dwordx4 v14, s[36:39], s66 offen lds
    s_waitcnt vmcnt(11)
    v_mfma_f32_32x32x16_bf16 v[32:47], a[4:7], a[96:99], 0
    s_add_u32 m0, s3, 147456
    s_nop 0
    buffer_load_dwordx4 v211, s[36:39], s67 offen lds
    s_waitcnt vmcnt(11)
    v_mfma_f32_32x32x16_bf16 v[32:47], a[12:15], a[100:103], v[32:47]
    ds_write_b128 v130, v[48:51] offset:18432
    ds_write_b128 v130, v[52:55] offset:19456
    s_waitcnt vmcnt(10)
    v_mfma_f32_32x32x16_bf16 v[32:47], a[20:23], a[104:107], v[32:47]
    ds_write_b128 v130, v[56:59] offset:20480
    s_add_u32 m0, s3, 148480
    s_waitcnt vmcnt(9)
    v_mfma_f32_32x32x16_bf16 v[32:47], a[28:31], a[108:111], v[32:47]
    ds_write_b128 v130, v[60:63] offset:21504
    buffer_load_dwordx4 v14, s[36:39], s67 offen lds
    s_waitcnt vmcnt(9)
    v_mfma_f32_32x32x16_bf16 v[32:47], a[36:39], a[112:115], v[32:47]
    ds_write_b128 v131, v[64:67] offset:34816
    s_add_u32 m0, s3, 155648
    s_waitcnt vmcnt(8)
    v_mfma_f32_32x32x16_bf16 v[32:47], a[44:47], a[116:119], v[32:47]
    ds_write_b128 v131, v[68:71] offset:35840
    buffer_load_dwordx4 v211, s[36:39], s95 offen lds
    s_waitcnt vmcnt(8)
    v_mfma_f32_32x32x16_bf16 v[32:47], a[52:55], a[120:123], v[32:47]
    ds_write_b128 v131, v[72:75] offset:36864
    s_add_u32 m0, s3, 156672
    s_waitcnt vmcnt(7)
    v_mfma_f32_32x32x16_bf16 v[32:47], a[60:63], a[124:127], v[32:47]
    ds_write_b128 v131, v[76:79] offset:37888
    buffer_load_dwordx4 v14, s[36:39], s95 offen lds
    v_mfma_f32_32x32x16_bf16 v[16:31], a[0:3], a[96:99], v[132:147]
    v_mfma_f32_32x32x16_bf16 v[16:31], a[8:11], a[100:103], v[16:31]
    s_waitcnt lgkmcnt(0)
    s_barrier
    ds_read_b128 v[96:99], v128 offset:18432
    ds_read_b128 v[100:103], v128 offset:19456
    ds_read_b128 v[104:107], v128 offset:20480
    ds_read_b128 v[108:111], v128 offset:21504
    v_mfma_f32_32x32x16_bf16 v[16:31], a[16:19], a[104:107], v[16:31]
    ds_read_b128 v[112:115], v128 offset:34816
    ds_read_b128 v[116:119], v128 offset:35840
    ds_read_b128 v[120:123], v128 offset:36864
    ds_read_b128 v[124:127], v128 offset:37888
    v_mfma_f32_32x32x16_bf16 v[16:31], a[24:27], a[108:111], v[16:31]
    ds_write_b128 v129, v[32:35] offset:2048
    v_mfma_f32_32x32x16_bf16 v[16:31], a[32:35], a[112:115], v[16:31]
    ds_write_b128 v129, v[36:39] offset:3072
    v_mfma_f32_32x32x16_bf16 v[16:31], a[40:43], a[116:119], v[16:31]
    ds_write_b128 v129, v[40:43] offset:4096
    v_mfma_f32_32x32x16_bf16 v[16:31], a[48:51], a[120:123], v[16:31]
    ds_write_b128 v129, v[44:47] offset:5120
    v_mfma_f32_32x32x16_bf16 v[16:31], a[56:59], a[124:127], v[16:31]
    s_waitcnt lgkmcnt(0)
    s_barrier
    ds_read_b128 v[80:83], v128 offset:2048
    ds_read_b128 v[84:87], v128 offset:3072
    ds_read_b128 v[88:91], v128 offset:4096
    ds_read_b128 v[92:95], v128 offset:5120
    v_pk_add_f32 v[96:97], v[96:97], v[112:113]
    v_pk_add_f32 v[98:99], v[98:99], v[114:115]
    v_pk_add_f32 v[100:101], v[100:101], v[116:117]
    v_pk_add_f32 v[102:103], v[102:103], v[118:119]
    v_pk_add_f32 v[104:105], v[104:105], v[120:121]
    v_pk_add_f32 v[106:107], v[106:107], v[122:123]
    v_pk_add_f32 v[108:109], v[108:109], v[124:125]
    v_pk_add_f32 v[110:111], v[110:111], v[126:127]
    v_pk_add_f32 v[16:17], v[16:17], v[96:97]
    v_pk_add_f32 v[18:19], v[18:19], v[98:99]
    v_pk_add_f32 v[20:21], v[20:21], v[100:101]
    v_pk_add_f32 v[22:23], v[22:23], v[102:103]
    v_pk_add_f32 v[24:25], v[24:25], v[104:105]
    v_pk_add_f32 v[26:27], v[26:27], v[106:107]
    v_pk_add_f32 v[28:29], v[28:29], v[108:109]
    v_pk_add_f32 v[30:31], v[30:31], v[110:111]
    s_waitcnt lgkmcnt(0)
    v_pk_add_f32 v[16:17], v[16:17], v[80:81]
    v_pk_add_f32 v[18:19], v[18:19], v[82:83]
    v_pk_add_f32 v[20:21], v[20:21], v[84:85]
    v_pk_add_f32 v[22:23], v[22:23], v[86:87]
    v_cvt_pk_bf16_f32 v2, v16, v17
    v_cvt_pk_bf16_f32 v3, v18, v19
    v_cvt_pk_bf16_f32 v4, v20, v21
    v_cvt_pk_bf16_f32 v5, v22, v23
    buffer_store_dwordx4 v[2:5], v1, s[48:51], s8 offen offset:0 sc1
    v_pk_add_f32 v[24:25], v[24:25], v[88:89]
    v_pk_add_f32 v[26:27], v[26:27], v[90:91]
    v_pk_add_f32 v[28:29], v[28:29], v[92:93]
    v_pk_add_f32 v[30:31], v[30:31], v[94:95]
    v_cvt_pk_bf16_f32 v6, v24, v25
    v_cvt_pk_bf16_f32 v7, v26, v27
    v_cvt_pk_bf16_f32 v8, v28, v29
    v_cvt_pk_bf16_f32 v9, v30, v31
    buffer_store_dwordx4 v[6:9], v1, s[48:51], s8 offen offset:1024 sc1
    s_mov_b32 s77, 1065369472
    v_dot2_f32_bf16 v132, v2, s77, 0
    v_dot2_f32_bf16 v133, v2, v2, 0
    v_dot2_f32_bf16 v132, v3, s77, v132
    v_dot2_f32_bf16 v133, v3, v3, v133
    v_dot2_f32_bf16 v132, v4, s77, v132
    v_dot2_f32_bf16 v133, v4, v4, v133
    v_dot2_f32_bf16 v132, v5, s77, v132
    v_dot2_f32_bf16 v133, v5, v5, v133
    v_dot2_f32_bf16 v132, v6, s77, v132
    v_dot2_f32_bf16 v133, v6, v6, v133
    v_dot2_f32_bf16 v132, v7, s77, v132
    v_dot2_f32_bf16 v133, v7, v7, v133
    v_dot2_f32_bf16 v132, v8, s77, v132
    v_dot2_f32_bf16 v133, v8, v8, v133
    v_dot2_f32_bf16 v132, v9, s77, v132
    v_dot2_f32_bf16 v133, v9, v9, v133
    s_nop 2
    v_permlane32_swap_b32 v132, v133
    v_add_f32 v132, v132, v133
    buffer_store_dword v132, v148, s[48:51], s79 offen  sc1
    s_add_u32 m0, s3, 18432
    s_add_u32 s0, s101, 0
    buffer_load_dwordx4 v210, s[40:43], s0 offen lds
    s_add_u32 m0, s3, 19456
    s_add_u32 s0, s101, 8192
    buffer_load_dwordx4 v210, s[40:43], s0 offen lds
    s_add_u32 m0, s3, 65536
    s_nop 0
    buffer_load_dwordx4 v211, s[36:39], s96 offen lds
    s_add_u32 m0, s3, 66560
    s_nop 0
    buffer_load_dwordx4 v14, s[36:39], s96 offen lds
    s_add_u32 m0, s3, 32768
    s_add_u32 s0, s101, 131072
    buffer_load_dwordx4 v210, s[40:43], s0 offen lds
    s_add_u32 m0, s3, 33792
    s_add_u32 s0, s101, 139264
    buffer_load_dwordx4 v210, s[40:43], s0 offen lds
    s_waitcnt vmcnt(6)
    v_mov_b32 v12, 1
    s_mov_b64 exec, 1
    buffer_store_dword v12, v11, s[52:55], s74 offen offset:256
    buffer_store_dword v12, v11, s[56:59], s74 offen offset:256 sc1
    s_mov_b64 exec, -1
    s_cmp_ge_u32 s75, 14
    s_cbranch_scc1 L_idle_20
    buffer_load_dword v12, v222, s[48:51], s74 offen offset:256 sc1
    v_bfe_u32 v95, v0, 4, 1
    v_lshl_add_u32 v212, v95, 12, v212
    v_bfe_u32 v10, v0, 3, 1
    v_lshl_or_b32 v10, v95, 1, v10
    v_lshl_add_u32 v212, v10, 5, v212
    s_lshl_b32 s76, s68, 5
    v_xor_b32 v212, s76, v212
    v_add_u32 v212, 32768, v212
    v_xor_b32 v213, 32, v212
    v_xor_b32 v214, 64, v212
    v_xor_b32 v215, 96, v212
    v_add_u32 v216, 65536, v212
    v_add_u32 v217, 65536, v213
    v_add_u32 v218, 65536, v214
    v_add_u32 v219, 65536, v215
    s_lshl_b32 s7, s69, 2
    s_add_u32 s7, s7, s68
    s_mul_i32 s7, s7, 28
    s_add_u32 s7, s7, s75
    s_lshl_b32 s7, s7, 12
    s_add_u32 s7, s7, 4194304
    s_mov_b32 vcc_lo, 131073
    s_mov_b32 vcc_hi, 131073
    v_mov_b32 v10, 1065369472
    v_cndmask_b32 v224, 0, v10, vcc
    v_cndmask_b32 v225, 0, v10, vcc
    v_cndmask_b32 v226, 0, v10, vcc
    v_cndmask_b32 v227, 0, v10, vcc
    v_and_b32 v10, 1, v0
    v_lshlrev_b32 v10, 8, v10
    v_lshrrev_b32 v95, 4, v0
    v_lshl_add_u32 v10, v95, 4, v10
    s_lshl_b32 s76, s68, 6
    v_add_u32 v238, s76, v10
    v_and_b32 v10, 15, v0
    v_lshlrev_b32 v10, 2, v10
    v_and_b32 v95, 1, v95
    v_lshl_add_u32 v10, v95, 8, v10
    v_add_u32 v239, s76, v10
    v_mov_b32 v194, 0
    v_mov_b32 v195, 0
    v_mov_b32 v198, 0
    v_mov_b32 v199, 0
    s_lshl_b32 s86, s69, 2
    s_add_u32 s86, s86, s68
    s_lshl_b32 s87, s86, 12
    s_add_u32 s87, s87, 11534336
    s_lshl_b32 s86, s86, 15
    s_add_u32 s86, s86, 2097152
    s_mul_i32 s85, s94, 4096
    s_mov_b64 exec, 0
    s_branch L_pad_3
L_walk_2:
    s_mov_b64 exec, -1
    s_waitcnt vmcnt(0)
    s_mov_b32 s84, 0
L_spinh_21:
    v_cmp_gt_u32 vcc, 1, v12
    s_add_u32 s84, s84, 1
    s_cbranch_vccz L_doneh_22
    buffer_load_dword v12, v222, s[48:51], s74 offen offset:256 sc1
    s_cmp_ge_u32 s84, 400000
    s_waitcnt vmcnt(0)
    s_cbranch_scc0 L_spinh_21
L_doneh_22:
    s_add_u32 s81, s86, s85
    buffer_load_dwordx4 a[0:3], v1, s[48:51], s81 offen offset:0 sc1
    s_add_u32 s85, s85, 4096
    s_and_b32 s85, s85, 0x7fff
    buffer_load_dwordx4 a[4:7], v1, s[48:51], s81 offen offset:1024 sc1
    buffer_load_dwordx4 a[8:11], v1, s[48:51], s81 offen offset:2048 sc1
    buffer_load_dwordx4 a[12:15], v1, s[48:51], s81 offen offset:3072 sc1
    s_add_u32 s81, s86, s85
    buffer_load_dwordx4 a[16:19], v1, s[48:51], s81 offen offset:0 sc1
    s_add_u32 s85, s85, 4096
    s_and_b32 s85, s85, 0x7fff
    buffer_load_dwordx4 a[20:23], v1, s[48:51], s81 offen offset:1024 sc1
    buffer_load_dwordx4 a[24:27], v1, s[48:51], s81 offen offset:2048 sc1
    buffer_load_dwordx4 a[28:31], v1, s[48:51], s81 offen offset:3072 sc1
    s_barrier
    ds_read_b64_tr_b16 v[144:145], v212 offset:49152
    ds_read_b64_tr_b16 v[146:147], v212 offset:50176
    ds_read_b64_tr_b16 v[148:149], v213 offset:49152
    ds_read_b64_tr_b16 v[150:151], v213 offset:50176
    ds_read_b64_tr_b16 v[152:153], v214 offset:49152
    ds_read_b64_tr_b16 v[154:155], v214 offset:50176
    ds_read_b64_tr_b16 v[156:157], v215 offset:49152
    ds_read_b64_tr_b16 v[158:159], v215 offset:50176
    ds_read_b64_tr_b16 v[160:161], v212 offset:51200
    ds_read_b64_tr_b16 v[162:163], v212 offset:52224
    ds_read_b64_tr_b16 v[164:165], v213 offset:51200
    ds_read_b64_tr_b16 v[166:167], v213 offset:52224
    ds_read_b64_tr_b16 v[168:169], v214 offset:51200
    ds_read_b64_tr_b16 v[170:171], v214 offset:52224
    ds_read_b64_tr_b16 v[172:173], v215 offset:51200
    ds_read_b64_tr_b16 v[174:175], v215 offset:52224
    s_waitcnt vmcnt(7) lgkmcnt(8)
    v_mfma_f32_32x32x16_bf16 v[16:31], v[144:147], a[0:3], 0
    s_add_u32 s81, s86, s85
    buffer_load_dwordx4 a[32:35], v1, s[48:51], s81 offen offset:0 sc1
    s_add_u32 s85, s85, 4096
    ds_read_b64_tr_b16 v[176:177], v212 offset:57344
    ds_read_b64_tr_b16 v[178:179], v212 offset:58368
    v_mfma_f32_16x16x32_bf16 v[228:231], v[144:147], v[224:227], 0
    ds_read_b64_tr_b16 v[180:181], v213 offset:57344
    v_mfma_f32_32x32x16_bf16 v[32:47], v[148:151], a[0:3], 0
    s_and_b32 s85, s85, 0x7fff
    ds_read_b64_tr_b16 v[182:183], v213 offset:58368
    ds_read_b64_tr_b16 v[184:185], v214 offset:57344
    ds_read_b64_tr_b16 v[186:187], v214 offset:58368
    v_mfma_f32_32x32x16_bf16 v[48:63], v[152:155], a[0:3], 0
    ds_read_b64_tr_b16 a[128:129], v208 offset:18432
    ds_read_b64_tr_b16 a[132:133], v209 offset:18432
    ds_read_b64_tr_b16 v[188:189], v215 offset:57344
    v_mfma_f32_32x32x16_bf16 v[64:79], v[156:159], a[0:3], 0
    buffer_load_dwordx4 a[36:39], v1, s[48:51], s81 offen offset:1024 sc1
    ds_read_b64_tr_b16 a[130:131], v208 offset:19456
    ds_read_b64_tr_b16 a[134:135], v209 offset:19456
    ds_read_b64_tr_b16 v[190:191], v215 offset:58368
    s_waitcnt vmcnt(8) lgkmcnt(12)
    v_mfma_f32_32x32x16_bf16 v[16:31], v[160:163], a[4:7], v[16:31]
    s_add_u32 m0, s3, 2048
    s_add_u32 s0, s101, 262144
    buffer_load_dwordx4 v210, s[40:43], s0 offen lds
    ds_read_b64_tr_b16 v[144:145], v212 offset:59392
    ds_read_b64_tr_b16 v[146:147], v212 offset:60416
    v_mfma_f32_16x16x32_bf16 v[228:231], v[160:163], v[224:227], v[228:231]
    ds_read_b64_tr_b16 v[148:149], v213 offset:59392
    v_mfma_f32_32x32x16_bf16 v[32:47], v[164:167], a[4:7], v[32:47]
    ds_read_b64_tr_b16 a[136:137], v208 offset:32768
    ds_read_b64_tr_b16 v[150:151], v213 offset:60416
    ds_read_b64_tr_b16 v[152:153], v214 offset:59392
    v_mfma_f32_32x32x16_bf16 v[48:63], v[168:171], a[4:7], v[48:63]
    buffer_load_dwordx4 a[40:43], v1, s[48:51], s81 offen offset:2048 sc1
    ds_read_b64_tr_b16 a[140:141], v209 offset:32768
    ds_read_b64_tr_b16 v[154:155], v214 offset:60416
    ds_read_b64_tr_b16 v[156:157], v215 offset:59392
    v_mfma_f32_32x32x16_bf16 v[64:79], v[172:175], a[4:7], v[64:79]
    ds_read_b64_tr_b16 a[138:139], v208 offset:33792
    ds_read_b64_tr_b16 a[142:143], v209 offset:33792
    ds_read_b64_tr_b16 v[158:159], v215 offset:60416
    s_waitcnt vmcnt(9) lgkmcnt(12)
    v_mfma_f32_32x32x16_bf16 v[16:31], v[176:179], a[8:11], v[16:31]
    s_add_u32 m0, s3, 3072
    s_add_u32 s0, s101, 270336
    buffer_load_dwordx4 v210, s[40:43], s0 offen lds
    ds_read_b64_tr_b16 v[160:161], v216 offset:0
    ds_read_b64_tr_b16 v[162:163], v216 offset:1024
    v_mfma_f32_16x16x32_bf16 v[228:231], v[176:179], v[224:227], v[228:231]
    ds_read_b64_tr_b16 v[164:165], v217 offset:0
    v_mfma_f32_32x32x16_bf16 v[32:47], v[180:183], a[8:11], v[32:47]
    buffer_load_dwordx4 a[44:47], v1, s[48:51], s81 offen offset:3072 sc1
    ds_read_b64_tr_b16 v[166:167], v217 offset:1024
    ds_read_b64_tr_b16 v[168:169], v218 offset:0
    ds_read_b64_tr_b16 v[170:171], v218 offset:1024
    v_mfma_f32_32x32x16_bf16 v[48:63], v[184:187], a[8:11], v[48:63]
    ds_read_b64_tr_b16 v[172:173], v219 offset:0
    ds_read_b64_tr_b16 v[174:175], v219 offset:1024
    v_mfma_f32_32x32x16_bf16 v[64:79], v[188:191], a[8:11], v[64:79]
    s_waitcnt vmcnt(10) lgkmcnt(8)
    v_mfma_f32_32x32x16_bf16 v[16:31], v[144:147], a[12:15], v[16:31]
    s_add_u32 s81, s86, s85
    buffer_load_dwordx4 a[48:51], v1, s[48:51], s81 offen offset:0 sc1
    s_add_u32 s85, s85, 4096
    ds_read_b64_tr_b16 v[176:177], v216 offset:2048
    ds_read_b64_tr_b16 v[178:179], v216 offset:3072
    v_mfma_f32_16x16x32_bf16 v[228:231], v[144:147], v[224:227], v[228:231]
    ds_read_b64_tr_b16 v[180:181], v217 offset:2048
    v_mfma_f32_32x32x16_bf16 v[32:47], v[148:151], a[12:15], v[32:47]
    s_and_b32 s85, s85, 0x7fff
    s_add_u32 m0, s3, 73728
    ds_read_b64_tr_b16 v[182:183], v217 offset:3072
    buffer_load_dwordx4 v211, s[36:39], s88 offen lds
    ds_read_b64_tr_b16 v[184:185], v218 offset:2048
    v_mfma_f32_32x32x16_bf16 v[48:63], v[152:155], a[12:15], v[48:63]
    ds_read_b64_tr_b16 v[186:187], v218 offset:3072
    ds_read_b64_tr_b16 v[188:189], v219 offset:2048
    ds_read_b64_tr_b16 v[190:191], v219 offset:3072
    v_mfma_f32_32x32x16_bf16 v[64:79], v[156:159], a[12:15], v[64:79]
    buffer_load_dwordx4 a[52:55], v1, s[48:51], s81 offen offset:1024 sc1
    s_waitcnt vmcnt(12) lgkmcnt(8)
    v_mfma_f32_32x32x16_bf16 v[16:31], v[160:163], a[16:19], v[16:31]
    s_barrier
    ds_read_b64_tr_b16 v[144:145], v216 offset:8192
    ds_read_b64_tr_b16 v[146:147], v216 offset:9216
    ds_read_b64_tr_b16 v[148:149], v217 offset:8192
    v_mfma_f32_16x16x32_bf16 v[228:231], v[160:163], v[224:227], v[228:231]
    ds_read_b64_tr_b16 v[150:151], v217 offset:9216
    v_mfma_f32_32x32x16_bf16 v[32:47], v[164:167], a[16:19], v[32:47]
    s_add_u32 m0, s3, 74752
    ds_read_b64_tr_b16 v[152:153], v218 offset:8192
    buffer_load_dwordx4 v14, s[36:39], s88 offen lds
    ds_read_b64_tr_b16 v[154:155], v218 offset:9216
    ds_read_b64_tr_b16 v[156:157], v219 offset:8192
    v_mfma_f32_32x32x16_bf16 v[48:63], v[168:171], a[16:19], v[48:63]
    buffer_load_dwordx4 a[56:59], v1, s[48:51], s81 offen offset:2048 sc1
    ds_read_b64_tr_b16 v[158:159], v219 offset:9216
    v_mfma_f32_32x32x16_bf16 v[64:79], v[172:175], a[16:19], v[64:79]
    s_waitcnt vmcnt(13) lgkmcnt(8)
    v_mfma_f32_32x32x16_bf16 v[16:31], v[176:179], a[20:23], v[16:31]
    ds_read_b64_tr_b16 v[160:161], v216 offset:10240
    ds_read_b64_tr_b16 v[162:163], v216 offset:11264
    ds_read_b64_tr_b16 v[164:165], v217 offset:10240
    v_mfma_f32_16x16x32_bf16 v[228:231], v[176:179], v[224:227], v[228:231]
    ds_read_b64_tr_b16 v[166:167], v217 offset:11264
    v_mfma_f32_32x32x16_bf16 v[32:47], v[180:183], a[20:23], v[32:47]
    buffer_load_dwordx4 a[60:63], v1, s[48:51], s81 offen offset:3072 sc1
    ds_read_b64_tr_b16 v[168:169], v218 offset:10240
    ds_read_b64_tr_b16 v[170:171], v218 offset:11264
    ds_read_b64_tr_b16 v[172:173], v219 offset:10240
    v_mfma_f32_32x32x16_bf16 v[48:63], v[184:187], a[20:23], v[48:63]
    s_add_u32 m0, s3, 81920
    ds_read_b64_tr_b16 v[174:175], v219 offset:11264
    buffer_load_dwordx4 v211, s[36:39], s89 offen lds
    v_mfma_f32_32x32x16_bf16 v[64:79], v[188:191], a[20:23], v[64:79]
    s_waitcnt vmcnt(14) lgkmcnt(8)
    v_mfma_f32_32x32x16_bf16 v[16:31], v[144:147], a[24:27], v[16:31]
    s_add_u32 s81, s86, s85
    buffer_load_dwordx4 a[64:67], v1, s[48:51], s81 offen offset:0 sc1
    s_add_u32 s85, s85, 4096
    ds_read_b64_tr_b16 v[176:177], v216 offset:16384
    ds_read_b64_tr_b16 v[178:179], v216 offset:17408
    v_mfma_f32_16x16x32_bf16 v[228:231], v[144:147], v[224:227], v[228:231]
    ds_read_b64_tr_b16 v[180:181], v217 offset:16384
    v_mfma_f32_32x32x16_bf16 v[32:47], v[148:151], a[24:27], v[32:47]
    s_and_b32 s85, s85, 0x7fff
    ds_read_b64_tr_b16 v[182:183], v217 offset:17408
    ds_read_b64_tr_b16 v[184:185], v218 offset:16384
    ds_read_b64_tr_b16 v[186:187], v218 offset:17408
    v_mfma_f32_32x32x16_bf16 v[48:63], v[152:155], a[24:27], v[48:63]
    ds_read_b64_tr_b16 v[188:189], v219 offset:16384
    ds_read_b64_tr_b16 v[190:191], v219 offset:17408
    v_mfma_f32_32x32x16_bf16 v[64:79], v[156:159], a[24:27], v[64:79]
    buffer_load_dwordx4 a[68:71], v1, s[48:51], s81 offen offset:1024 sc1
    s_add_u32 m0, s3, 82944
    s_waitcnt vmcnt(15) lgkmcnt(8)
    v_mfma_f32_32x32x16_bf16 v[16:31], v[160:163], a[28:31], v[16:31]
    buffer_load_dwordx4 v14, s[36:39], s89 offen lds
    ds_read_b64_tr_b16 v[144:145], v216 offset:18432
    ds_read_b64_tr_b16 v[146:147], v216 offset:19456
    ds_read_b64_tr_b16 v[148:149], v217 offset:18432
    v_mfma_f32_16x16x32_bf16 v[228:231], v[160:163], v[224:227], v[228:231]
    ds_read_b64_tr_b16 v[150:151], v217 offset:19456
    v_mfma_f32_32x32x16_bf16 v[32:47], v[164:167], a[28:31], v[32:47]
    ds_read_b64_tr_b16 v[152:153], v218 offset:18432
    ds_read_b64_tr_b16 v[154:155], v218 offset:19456
    ds_read_b64_tr_b16 v[156:157], v219 offset:18432
    v_mfma_f32_32x32x16_bf16 v[48:63], v[168:171], a[28:31], v[48:63]
    buffer_load_dwordx4 a[72:75], v1, s[48:51], s81 offen offset:2048 sc1
    ds_read_b64_tr_b16 v[158:159], v219 offset:19456
    v_mfma_f32_32x32x16_bf16 v[64:79], v[172:175], a[28:31], v[64:79]
    s_waitcnt vmcnt(16) lgkmcnt(8)
    v_mfma_f32_32x32x16_bf16 v[16:31], v[176:179], a[32:35], v[16:31]
    s_barrier
    s_add_u32 m0, s3, 90112
    ds_read_b64_tr_b16 v[160:161], v216 offset:24576
    buffer_load_dwordx4 v211, s[36:39], s90 offen lds
    ds_read_b64_tr_b16 v[162:163], v216 offset:25600
    v_mfma_f32_16x16x32_bf16 v[228:231], v[176:179], v[224:227], v[228:231]
    ds_read_b64_tr_b16 v[164:165], v217 offset:24576
    v_mfma_f32_32x32x16_bf16 v[32:47], v[180:183], a[32:35], v[32:47]
    buffer_load_dwordx4 a[76:79], v1, s[48:51], s81 offen offset:3072 sc1
    ds_read_b64_tr_b16 v[166:167], v217 offset:25600
    ds_read_b64_tr_b16 v[168:169], v218 offset:24576
    ds_read_b64_tr_b16 v[170:171], v218 offset:25600
    v_mfma_f32_32x32x16_bf16 v[48:63], v[184:187], a[32:35], v[48:63]
    ds_read_b64_tr_b16 v[172:173], v219 offset:24576
    ds_read_b64_tr_b16 v[174:175], v219 offset:25600
    v_mfma_f32_32x32x16_bf16 v[64:79], v[188:191], a[32:35], v[64:79]
    s_waitcnt vmcnt(17) lgkmcnt(8)
    v_mfma_f32_32x32x16_bf16 v[16:31], v[144:147], a[36:39], v[16:31]
    s_add_u32 s81, s86, s85
    buffer_load_dwordx4 a[80:83], v1, s[48:51], s81 offen offset:0 sc1
    s_add_u32 s85, s85, 4096
    ds_read_b64_tr_b16 v[176:177], v216 offset:26624
    ds_read_b64_tr_b16 v[178:179], v216 offset:27648
    v_mfma_f32_16x16x32_bf16 v[228:231], v[144:147], v[224:227], v[228:231]
    ds_read_b64_tr_b16 v[180:181], v217 offset:26624
    v_mfma_f32_32x32x16_bf16 v[32:47], v[148:151], a[36:39], v[32:47]
    s_and_b32 s85, s85, 0x7fff
    s_add_u32 m0, s3, 91136
    ds_read_b64_tr_b16 v[182:183], v217 offset:27648
    buffer_load_dwordx4 v14, s[36:39], s90 offen lds
    ds_read_b64_tr_b16 v[184:185], v218 offset:26624
    v_mfma_f32_32x32x16_bf16 v[48:63], v[152:155], a[36:39], v[48:63]
    ds_read_b64_tr_b16 v[186:187], v218 offset:27648
    ds_read_b64_tr_b16 v[188:189], v219 offset:26624
    ds_read_b64_tr_b16 v[190:191], v219 offset:27648
    v_mfma_f32_32x32x16_bf16 v[64:79], v[156:159], a[36:39], v[64:79]
    buffer_load_dwordx4 a[84:87], v1, s[48:51], s81 offen offset:1024 sc1
    s_waitcnt vmcnt(18) lgkmcnt(8)
    v_mfma_f32_32x32x16_bf16 v[16:31], v[160:163], a[40:43], v[16:31]
    buffer_load_dwordx4 v[80:83], v1, s[48:51], s87 offen offset:0 sc1
    ds_read_b64_tr_b16 v[144:145], v216 offset:32768
    ds_read_b64_tr_b16 v[146:147], v216 offset:33792
    ds_read_b64_tr_b16 v[148:149], v217 offset:32768
    v_mfma_f32_16x16x32_bf16 v[228:231], v[160:163], v[224:227], v[228:231]
    ds_read_b64_tr_b16 v[150:151], v217 offset:33792
    v_mfma_f32_32x32x16_bf16 v[32:47], v[164:167], a[40:43], v[32:47]
    buffer_load_dwordx4 v[84:87], v1, s[48:51], s87 offen offset:1024 sc1
    ds_read_b64_tr_b16 v[152:153], v218 offset:32768
    ds_read_b64_tr_b16 v[154:155], v218 offset:33792
    ds_read_b64_tr_b16 v[156:157], v219 offset:32768
    v_mfma_f32_32x32x16_bf16 v[48:63], v[168:171], a[40:43], v[48:63]
    buffer_load_dwordx4 a[88:91], v1, s[48:51], s81 offen offset:2048 sc1
    s_add_u32 m0, s3, 98304
    ds_read_b64_tr_b16 v[158:159], v219 offset:33792
    v_mfma_f32_32x32x16_bf16 v[64:79], v[172:175], a[40:43], v[64:79]
    buffer_load_dwordx4 v211, s[36:39], s91 offen lds
    s_waitcnt vmcnt(20) lgkmcnt(8)
    v_mfma_f32_32x32x16_bf16 v[16:31], v[176:179], a[44:47], v[16:31]
    buffer_load_dwordx4 v[88:91], v1, s[48:51], s87 offen offset:2048 sc1
    ds_read_b64_tr_b16 v[160:161], v216 offset:34816
    ds_read_b64_tr_b16 v[162:163], v216 offset:35840
    ds_read_b64_tr_b16 v[164:165], v217 offset:34816
    v_mfma_f32_16x16x32_bf16 v[228:231], v[176:179], v[224:227], v[228:231]
    ds_read_b64_tr_b16 v[166:167], v217 offset:35840
    v_mfma_f32_32x32x16_bf16 v[32:47], v[180:183], a[44:47], v[32:47]
    buffer_load_dwordx4 a[92:95], v1, s[48:51], s81 offen offset:3072 sc1
    ds_read_b64_tr_b16 v[168:169], v218 offset:34816
    ds_read_b64_tr_b16 v[170:171], v218 offset:35840
    ds_read_b64_tr_b16 v[172:173], v219 offset:34816
    v_mfma_f32_32x32x16_bf16 v[48:63], v[184:187], a[44:47], v[48:63]
    buffer_load_dwordx4 v[92:95], v1, s[48:51], s87 offen offset:3072 sc1
    ds_read_b64_tr_b16 v[174:175], v219 offset:35840
    v_mfma_f32_32x32x16_bf16 v[64:79], v[188:191], a[44:47], v[64:79]
    s_add_u32 m0, s3, 99328
    s_nop 0
    buffer_load_dwordx4 v14, s[36:39], s91 offen lds
    s_waitcnt vmcnt(23) lgkmcnt(8)
    v_mfma_f32_32x32x16_bf16 v[16:31], v[144:147], a[48:51], v[16:31]
    s_barrier
    s_add_u32 s81, s86, s85
    buffer_load_dwordx4 a[96:99], v1, s[48:51], s81 offen offset:0 sc1
    ds_read_b64_tr_b16 v[176:177], v216 offset:40960
    ds_read_b64_tr_b16 v[178:179], v216 offset:41984
    v_mfma_f32_16x16x32_bf16 v[228:231], v[144:147], v[224:227], v[228:231]
    ds_read_b64_tr_b16 v[180:181], v217 offset:40960
    v_mfma_f32_32x32x16_bf16 v[32:47], v[148:151], a[48:51], v[32:47]
    s_add_u32 s85, s85, 4096
    s_and_b32 s85, s85, 0x7fff
    ds_read_b64_tr_b16 a[144:145], v208 offset:2048
    ds_read_b64_tr_b16 a[148:149], v209 offset:2048
    ds_read_b64_tr_b16 a[146:147], v208 offset:3072
    v_mfma_f32_32x32x16_bf16 v[48:63], v[152:155], a[48:51], v[48:63]
    ds_read_b64_tr_b16 a[150:151], v209 offset:3072
    ds_read_b64_tr_b16 v[182:183], v217 offset:41984
    ds_read_b64_tr_b16 v[184:185], v218 offset:40960
    v_mfma_f32_32x32x16_bf16 v[64:79], v[156:159], a[48:51], v[64:79]
    buffer_load_dwordx4 a[100:103], v1, s[48:51], s81 offen offset:1024 sc1
    ds_read_b64_tr_b16 v[186:187], v218 offset:41984
    ds_read_b64_tr_b16 v[188:189], v219 offset:40960
    ds_read_b64_tr_b16 v[190:191], v219 offset:41984
    s_waitcnt vmcnt(23) lgkmcnt(12)
    v_mfma_f32_32x32x16_bf16 v[16:31], v[160:163], a[52:55], v[16:31]
    s_add_u32 m0, s3, 106496
    ds_read_b64_tr_b16 v[144:145], v216 offset:43008
    buffer_load_dwordx4 v211, s[36:39], s1 offen lds
    ds_read_b64_tr_b16 v[146:147], v216 offset:44032
    ds_read_b64_tr_b16 v[148:149], v217 offset:43008
L_pad_1:
    s_cbranch_execz L_pad_2
    v_mfma_f32_16x16x32_bf16 v[228:231], v[160:163], v[224:227], v[228:231]
    ds_read_b64_tr_b16 v[150:151], v217 offset:44032
    v_mfma_f32_32x32x16_bf16 v[32:47], v[164:167], a[52:55], v[32:47]
    ds_read_b64_tr_b16 v[152:153], v218 offset:43008
    ds_read_b64_tr_b16 v[154:155], v218 offset:44032
    ds_read_b64_tr_b16 v[156:157], v219 offset:43008
    v_mfma_f32_32x32x16_bf16 v[48:63], v[168:171], a[52:55], v[48:63]
    buffer_load_dwordx4 a[104:107], v1, s[48:51], s81 offen offset:2048 sc1
    ds_read_b64_tr_b16 v[158:159], v219 offset:44032
    v_mfma_f32_32x32x16_bf16 v[64:79], v[172:175], a[52:55], v[64:79]
    s_waitcnt vmcnt(23) lgkmcnt(8)
    v_mfma_f32_32x32x16_bf16 v[16:31], v[176:179], a[56:59], v[16:31]
    ds_read_b64_tr_b16 v[160:161], v216 offset:49152
    ds_read_b64_tr_b16 v[162:163], v216 offset:50176
    ds_read_b64_tr_b16 v[164:165], v217 offset:49152
    v_mfma_f32_16x16x32_bf16 v[228:231], v[176:179], v[224:227], v[228:231]
    ds_read_b64_tr_b16 v[166:167], v217 offset:50176
    v_mfma_f32_32x32x16_bf16 v[32:47], v[180:183], a[56:59], v[32:47]
    buffer_load_dwordx4 a[108:111], v1, s[48:51], s81 offen offset:3072 sc1
    s_add_u32 m0, s3, 107520
    ds_read_b64_tr_b16 v[168:169], v218 offset:49152
    ds_read_b64_tr_b16 v[170:171], v218 offset:50176
    ds_read_b64_tr_b16 v[172:173], v219 offset:49152
    v_mfma_f32_32x32x16_bf16 v[48:63], v[184:187], a[56:59], v[48:63]
    buffer_load_dwordx4 v14, s[36:39], s1 offen lds
    ds_read_b64_tr_b16 v[174:175], v219 offset:50176
    v_mfma_f32_32x32x16_bf16 v[64:79], v[188:191], a[56:59], v[64:79]
    s_waitcnt vmcnt(24) lgkmcnt(8)
    v_mfma_f32_32x32x16_bf16 v[16:31], v[144:147], a[60:63], v[16:31]
    s_add_u32 s81, s86, s85
    buffer_load_dwordx4 a[112:115], v1, s[48:51], s81 offen offset:0 sc1
    s_add_u32 s85, s85, 4096
    ds_read_b64_tr_b16 v[176:177], v216 offset:51200
    ds_read_b64_tr_b16 v[178:179], v216 offset:52224
    v_mfma_f32_16x16x32_bf16 v[228:231], v[144:147], v[224:227], v[228:231]
    ds_read_b64_tr_b16 v[180:181], v217 offset:51200
    v_mfma_f32_32x32x16_bf16 v[32:47], v[148:151], a[60:63], v[32:47]
    s_and_b32 s85, s85, 0x7fff
    ds_read_b64_tr_b16 v[182:183], v217 offset:52224
    ds_read_b64_tr_b16 v[184:185], v218 offset:51200
    ds_read_b64_tr_b16 v[186:187], v218 offset:52224
    v_mfma_f32_32x32x16_bf16 v[48:63], v[152:155], a[60:63], v[48:63]
    v_add_u32 v211, 128, v211
    v_add_u32 v14, 128, v14
    s_add_u32 m0, s3, 114688
    ds_read_b64_tr_b16 v[188:189], v219 offset:51200
    buffer_load_dwordx4 v211, s[36:39], s16 offen lds
    v_mfma_f32_32x32x16_bf16 v[64:79], v[156:159], a[60:63], v[64:79]
    buffer_load_dwordx4 a[116:119], v1, s[48:51], s81 offen offset:1024 sc1
    ds_read_b64_tr_b16 v[190:191], v219 offset:52224
    s_waitcnt vmcnt(25) lgkmcnt(8)
    v_mfma_f32_32x32x16_bf16 v[16:31], v[160:163], a[64:67], v[16:31]
    s_barrier
    ds_read_b64_tr_b16 v[144:145], v216 offset:57344
    ds_read_b64_tr_b16 v[146:147], v216 offset:58368
    ds_read_b64_tr_b16 v[148:149], v217 offset:57344
    v_mfma_f32_16x16x32_bf16 v[228:231], v[160:163], v[224:227], v[228:231]
    ds_read_b64_tr_b16 v[150:151], v217 offset:58368
    v_mfma_f32_32x32x16_bf16 v[32:47], v[164:167], a[64:67], v[32:47]
    ds_read_b64_tr_b16 v[152:153], v218 offset:57344
    ds_read_b64_tr_b16 v[154:155], v218 offset:58368
    ds_read_b64_tr_b16 v[156:157], v219 offset:57344
    v_mfma_f32_32x32x16_bf16 v[48:63], v[168:171], a[64:67], v[48:63]
    buffer_load_dwordx4 a[120:123], v1, s[48:51], s81 offen offset:2048 sc1
    ds_read_b64_tr_b16 v[158:159], v219 offset:58368
    v_mfma_f32_32x32x16_bf16 v[64:79], v[172:175], a[64:67], v[64:79]
    s_add_u32 m0, s3, 115712
    s_nop 0
    buffer_load_dwordx4 v14, s[36:39], s16 offen lds
    s_waitcnt vmcnt(26) lgkmcnt(8)
    v_mfma_f32_32x32x16_bf16 v[16:31], v[176:179], a[68:71], v[16:31]
    ds_read_b64_tr_b16 v[160:161], v216 offset:59392
    ds_read_b64_tr_b16 v[162:163], v216 offset:60416
    ds_read_b64_tr_b16 v[164:165], v217 offset:59392
    v_mfma_f32_16x16x32_bf16 v[228:231], v[176:179], v[224:227], v[228:231]
    ds_read_b64_tr_b16 v[166:167], v217 offset:60416
    v_mfma_f32_32x32x16_bf16 v[32:47], v[180:183], a[68:71], v[32:47]
    buffer_load_dwordx4 a[124:127], v1, s[48:51], s81 offen offset:3072 sc1
    ds_read_b64_tr_b16 v[168:169], v218 offset:59392
    ds_read_b64_tr_b16 v[170:171], v218 offset:60416
    ds_read_b64_tr_b16 v[172:173], v219 offset:59392
    v_mfma_f32_32x32x16_bf16 v[48:63], v[184:187], a[68:71], v[48:63]
    ds_read_b64_tr_b16 v[174:175], v219 offset:60416
    v_mfma_f32_32x32x16_bf16 v[64:79], v[188:191], a[68:71], v[64:79]
    s_waitcnt vmcnt(25) lgkmcnt(8)
    v_mfma_f32_32x32x16_bf16 v[16:31], v[144:147], a[72:75], v[16:31]
    s_add_u32 m0, s3, 122880
    ds_read_b64_tr_b16 v[176:177], v212 offset:32768
    buffer_load_dwordx4 v211, s[36:39], s17 offen lds
    ds_read_b64_tr_b16 v[178:179], v212 offset:33792
    ds_read_b64_tr_b16 v[180:181], v213 offset:32768
    v_mfma_f32_16x16x32_bf16 v[228:231], v[144:147], v[224:227], v[228:231]
    ds_read_b64_tr_b16 v[182:183], v213 offset:33792
    v_mfma_f32_32x32x16_bf16 v[32:47], v[148:151], a[72:75], v[32:47]
    ds_read_b64_tr_b16 v[184:185], v214 offset:32768
    ds_read_b64_tr_b16 v[186:187], v214 offset:33792
    ds_read_b64_tr_b16 v[188:189], v215 offset:32768
    v_mfma_f32_32x32x16_bf16 v[48:63], v[152:155], a[72:75], v[48:63]
    s_add_u32 m0, s3, 123904
    ds_read_b64_tr_b16 v[190:191], v215 offset:33792
    buffer_load_dwordx4 v14, s[36:39], s17 offen lds
    v_mfma_f32_32x32x16_bf16 v[64:79], v[156:159], a[72:75], v[64:79]
    s_waitcnt vmcnt(25) lgkmcnt(8)
    v_mfma_f32_32x32x16_bf16 v[16:31], v[160:163], a[76:79], v[16:31]
    s_add_u32 m0, s3, 131072
    ds_read_b64_tr_b16 v[144:145], v212 offset:34816
    buffer_load_dwordx4 v211, s[36:39], s18 offen lds
    s_waitcnt vmcnt(16)
    v_add_f32 v80, v80, v88
    v_add_f32 v81, v81, v89
    v_mfma_f32_16x16x32_bf16 v[228:231], v[160:163], v[224:227], v[228:231]
    ds_read_b64_tr_b16 v[146:147], v212 offset:35840
    v_mfma_f32_32x32x16_bf16 v[32:47], v[164:167], a[76:79], v[32:47]
    v_add_f32 v82, v82, v90
    v_add_f32 v83, v83, v91
    v_add_f32 v84, v84, v92
    v_add_f32 v85, v85, v93
    v_add_f32 v86, v86, v94
    v_add_f32 v87, v87, v95
    v_add_f32 v80, v80, v84
    v_mfma_f32_32x32x16_bf16 v[48:63], v[168:171], a[76:79], v[48:63]
    s_add_u32 m0, s3, 132096
    ds_read_b64_tr_b16 v[148:149], v213 offset:34816
    buffer_load_dwordx4 v14, s[36:39], s18 offen lds
    v_add_f32 v81, v81, v85
    ds_read_b64_tr_b16 v[150:151], v213 offset:35840
    ds_read_b64_tr_b16 v[152:153], v214 offset:34816
    v_mfma_f32_32x32x16_bf16 v[64:79], v[172:175], a[76:79], v[64:79]
    v_add_f32 v82, v82, v86
    v_add_f32 v83, v83, v87
    ds_read_b64_tr_b16 v[154:155], v214 offset:35840
    ds_read_b64_tr_b16 v[156:157], v215 offset:34816
    ds_read_b64_tr_b16 v[158:159], v215 offset:35840
    s_waitcnt lgkmcnt(8)
    v_mfma_f32_32x32x16_bf16 v[16:31], v[176:179], a[80:83], v[16:31]
    s_barrier
    s_add_u32 m0, s3, 139264
    ds_read_b64_tr_b16 v[160:161], v212 offset:40960
    buffer_load_dwordx4 v211, s[36:39], s21 offen lds
    ds_read_b64_tr_b16 v[162:163], v212 offset:41984
    v_mfma_f32_16x16x32_bf16 v[228:231], v[176:179], v[224:227], v[228:231]
    ds_read_b64_tr_b16 v[164:165], v213 offset:40960
    v_mfma_f32_32x32x16_bf16 v[32:47], v[180:183], a[80:83], v[32:47]
    v_permlane32_swap_b32 v80, v82
    v_permlane32_swap_b32 v81, v83
    v_add_f32 v80, v80, v82
    v_add_f32 v81, v81, v83
    ds_read_b64_tr_b16 v[166:167], v213 offset:41984
    v_mfma_f32_32x32x16_bf16 v[48:63], v[184:187], a[80:83], v[48:63]
    s_add_u32 m0, s3, 140288
    ds_read_b64_tr_b16 v[168:169], v214 offset:40960
    buffer_load_dwordx4 v14, s[36:39], s21 offen lds
    s_nop 1
    v_permlane16_swap_b32 v80, v81
    v_mfma_f32_32x32x16_bf16 v[64:79], v[188:191], a[80:83], v[64:79]
    v_add_f32 v80, v80, v81
    v_mul_f32 v80, 989855744, v80
    v_mov_b32 v81, v80
    ds_read_b64_tr_b16 v[170:171], v214 offset:41984
    ds_read_b64_tr_b16 v[172:173], v215 offset:40960
    ds_read_b64_tr_b16 v[174:175], v215 offset:41984
    s_waitcnt lgkmcnt(8)
    v_mfma_f32_32x32x16_bf16 v[16:31], v[144:147], a[84:87], v[16:31]
    s_add_u32 m0, s3, 147456
    ds_read_b64_tr_b16 v[176:177], v212 offset:43008
    buffer_load_dwordx4 v211, s[36:39], s22 offen lds
    s_nop 1
    v_permlane32_swap_b32 v80, v81
    v_mfma_f32_16x16x32_bf16 v[228:231], v[144:147], v[224:227], v[228:231]
    ds_read_b64_tr_b16 v[178:179], v212 offset:44032
    v_mfma_f32_32x32x16_bf16 v[32:47], v[148:151], a[84:87], v[32:47]
    v_fma_f32 v81, -v80, v80, v81
    v_max_f32 v81, 0, v81
    v_add_f32 v81, 925353388, v81
    v_rcp_f32 v81, v81
    s_lshl_b32 s76, s68, 7
    v_lshl_add_u32 v82, v0, 2, s76
    v_mfma_f32_32x32x16_bf16 v[48:63], v[152:155], a[84:87], v[48:63]
    s_add_u32 m0, s3, 148480
    ds_read_b64_tr_b16 v[180:181], v213 offset:43008
    buffer_load_dwordx4 v14, s[36:39], s22 offen lds
    ds_read_b64_tr_b16 v[182:183], v213 offset:44032
    ds_read_b64_tr_b16 v[184:185], v214 offset:43008
    v_mfma_f32_32x32x16_bf16 v[64:79], v[156:159], a[84:87], v[64:79]
    s_mov_b32 exec_hi, 0
    ds_write_b32 v82, v81 offset:0
    s_mov_b32 exec_hi, -1
    ds_read_b64_tr_b16 v[186:187], v214 offset:44032
    ds_read_b64_tr_b16 v[188:189], v215 offset:43008
    ds_read_b64_tr_b16 v[190:191], v215 offset:44032
    s_waitcnt lgkmcnt(9)
    v_mfma_f32_32x32x16_bf16 v[16:31], v[160:163], a[88:91], v[16:31]
    s_add_u32 m0, s3, 155648
    ds_read_b64_tr_b16 v[144:145], v212 offset:49152
    buffer_load_dwordx4 v211, s[36:39], s64 offen lds
    v_sub_f32 v80, 0, v80
    v_cvt_pk_bf16_f32 v232, v80, v80
    v_lshlrev_b32 v81, 16, v232
    v_mfma_f32_16x16x32_bf16 v[228:231], v[160:163], v[224:227], v[228:231]
    ds_read_b64_tr_b16 v[146:147], v212 offset:50176
    v_mfma_f32_32x32x16_bf16 v[32:47], v[164:167], a[88:91], v[32:47]
    v_sub_f32 v80, v80, v81
    v_cvt_pk_bf16_f32 v233, v80, v80
    v_mov_b32 v234, 0
    v_mov_b32 v235, 0
    ds_read_b64_tr_b16 v[148:149], v213 offset:49152
    ds_read_b64_tr_b16 v[150:151], v213 offset:50176
    ds_read_b64_tr_b16 v[152:153], v214 offset:49152
    v_mfma_f32_32x32x16_bf16 v[48:63], v[168:171], a[88:91], v[48:63]
    s_add_u32 m0, s3, 156672
    ds_read_b64_tr_b16 v[154:155], v214 offset:50176
    buffer_load_dwordx4 v14, s[36:39], s64 offen lds
    ds_read_b64_tr_b16 v[156:157], v215 offset:49152
    ds_read_b64_tr_b16 v[158:159], v215 offset:50176
    v_mfma_f32_32x32x16_bf16 v[64:79], v[172:175], a[88:91], v[64:79]
    s_mov_b32 exec_lo, 0
    v_mov_b32 v232, 0
    v_mov_b32 v233, 0
    s_mov_b32 exec_lo, -1
    s_waitcnt lgkmcnt(8)
    v_mfma_f32_32x32x16_bf16 v[16:31], v[176:179], a[92:95], v[16:31]
    s_add_u32 m0, s3, 40960
    ds_read_b64_tr_b16 v[160:161], v212 offset:51200
    buffer_load_dwordx4 v211, s[36:39], s65 offen lds
    ds_read_b64_tr_b16 v[162:163], v212 offset:52224
    ds_read_b64_tr_b16 v[164:165], v213 offset:51200
    v_mfma_f32_16x16x32_bf16 v[228:231], v[176:179], v[224:227], v[228:231]
    ds_read_b64_tr_b16 v[166:167], v213 offset:52224
    v_mfma_f32_32x32x16_bf16 v[32:47], v[180:183], a[92:95], v[32:47]
    ds_read_b64_tr_b16 v[168:169], v214 offset:51200
    ds_read_b64_tr_b16 v[170:171], v214 offset:52224
    ds_read_b64_tr_b16 v[172:173], v215 offset:51200
    v_mfma_f32_32x32x16_bf16 v[48:63], v[184:187], a[92:95], v[48:63]
    s_add_u32 m0, s3, 41984
    ds_read_b64_tr_b16 v[174:175], v215 offset:52224
    buffer_load_dwordx4 v14, s[36:39], s65 offen lds
    v_mfma_f32_32x32x16_bf16 v[64:79], v[188:191], a[92:95], v[64:79]
    s_waitcnt vmcnt(23) lgkmcnt(8)
    v_mfma_f32_32x32x16_bf16 v[16:31], v[144:147], a[96:99], v[16:31]
    s_barrier
    s_add_u32 m0, s3, 10240
    s_add_u32 s0, s101, 393216
    buffer_load_dwordx4 v210, s[40:43], s0 offen lds
    v_mfma_f32_16x16x32_bf16 v[228:231], v[144:147], v[224:227], v[228:231]
    ds_read_b64_tr_b16 v[176:177], v212 offset:57344
    v_mfma_f32_32x32x16_bf16 v[32:47], v[148:151], a[96:99], v[32:47]
    ds_read_b64_tr_b16 v[178:179], v212 offset:58368
    ds_read_b64_tr_b16 v[180:181], v213 offset:57344
    ds_read_b64_tr_b16 v[182:183], v213 offset:58368
    v_mfma_f32_32x32x16_bf16 v[48:63], v[152:155], a[96:99], v[48:63]
    s_add_u32 m0, s3, 11264
    s_add_u32 s0, s101, 401408
    buffer_load_dwordx4 v210, s[40:43], s0 offen lds
    ds_read_b64_tr_b16 v[184:185], v214 offset:57344
    ds_read_b64_tr_b16 v[186:187], v214 offset:58368
    v_mfma_f32_32x32x16_bf16 v[64:79], v[156:159], a[96:99], v[64:79]
    ds_read_b64_tr_b16 v[188:189], v215 offset:57344
    ds_read_b64_tr_b16 v[190:191], v215 offset:58368
    s_waitcnt vmcnt(24) lgkmcnt(8)
    v_mfma_f32_32x32x16_bf16 v[16:31], v[160:163], a[100:103], v[16:31]
    s_add_u32 m0, s3, 18432
    s_add_u32 s0, s101, 524288
    buffer_load_dwordx4 v210, s[40:43], s0 offen lds
    ds_read_b64_tr_b16 v[144:145], v212 offset:59392
    v_mfma_f32_16x16x32_bf16 v[228:231], v[160:163], v[224:227], v[228:231]
    ds_read_b64_tr_b16 v[146:147], v212 offset:60416
    v_mfma_f32_32x32x16_bf16 v[32:47], v[164:167], a[100:103], v[32:47]
    ds_read_b64_tr_b16 v[148:149], v213 offset:59392
    ds_read_b64_tr_b16 v[150:151], v213 offset:60416
    ds_read_b64_tr_b16 v[152:153], v214 offset:59392
    v_mfma_f32_32x32x16_bf16 v[48:63], v[168:171], a[100:103], v[48:63]
    s_add_u32 m0, s3, 19456
    s_add_u32 s0, s101, 532480
    buffer_load_dwordx4 v210, s[40:43], s0 offen lds
    ds_read_b64_tr_b16 v[154:155], v214 offset:60416
    ds_read_b64_tr_b16 v[156:157], v215 offset:59392
    v_mfma_f32_32x32x16_bf16 v[64:79], v[172:175], a[100:103], v[64:79]
    ds_read_b64_tr_b16 v[158:159], v215 offset:60416
    s_waitcnt vmcnt(24) lgkmcnt(8)
    v_mfma_f32_32x32x16_bf16 v[16:31], v[176:179], a[104:107], v[16:31]
    s_add_u32 m0, s3, 65536
    ds_read_b64_tr_b16 v[160:161], v216 offset:0
    buffer_load_dwordx4 v211, s[36:39], s66 offen lds
    ds_read_b64_tr_b16 v[162:163], v216 offset:1024
    ds_read_b64_tr_b16 v[164:165], v217 offset:0
    v_mfma_f32_16x16x32_bf16 v[228:231], v[176:179], v[224:227], v[228:231]
    ds_read_b64_tr_b16 v[166:167], v217 offset:1024
    v_mfma_f32_32x32x16_bf16 v[32:47], v[180:183], a[104:107], v[32:47]
    ds_read_b64_tr_b16 v[168:169], v218 offset:0
    ds_read_b64_tr_b16 v[170:171], v218 offset:1024
    ds_read_b64_tr_b16 v[172:173], v219 offset:0
    v_mfma_f32_32x32x16_bf16 v[48:63], v[184:187], a[104:107], v[48:63]
    s_add_u32 m0, s3, 66560
    ds_read_b64_tr_b16 v[174:175], v219 offset:1024
    buffer_load_dwordx4 v14, s[36:39], s66 offen lds
    v_mfma_f32_32x32x16_bf16 v[64:79], v[188:191], a[104:107], v[64:79]
    s_waitcnt vmcnt(25) lgkmcnt(8)
    v_mfma_f32_32x32x16_bf16 v[16:31], v[144:147], a[108:111], v[16:31]
    s_add_u32 m0, s3, 73728
    ds_read_b64_tr_b16 v[176:177], v216 offset:2048
    buffer_load_dwordx4 v211, s[36:39], s67 offen lds
    ds_read_b64_tr_b16 v[178:179], v216 offset:3072
    ds_read_b64_tr_b16 v[180:181], v217 offset:2048
    v_mfma_f32_16x16x32_bf16 v[228:231], v[144:147], v[224:227], v[228:231]
    ds_read_b64_tr_b16 v[182:183], v217 offset:3072
    v_mfma_f32_32x32x16_bf16 v[32:47], v[148:151], a[108:111], v[32:47]
    ds_read_b64_tr_b16 v[184:185], v218 offset:2048
    ds_read_b64_tr_b16 v[186:187], v218 offset:3072
    ds_read_b64_tr_b16 v[188:189], v219 offset:2048
    v_mfma_f32_32x32x16_bf16 v[48:63], v[152:155], a[108:111], v[48:63]
    s_add_u32 m0, s3, 74752
    ds_read_b64_tr_b16 v[190:191], v219 offset:3072
    buffer_load_dwordx4 v14, s[36:39], s67 offen lds
    v_mfma_f32_32x32x16_bf16 v[64:79], v[156:159], a[108:111], v[64:79]
    s_waitcnt vmcnt(25) lgkmcnt(8)
    v_mfma_f32_32x32x16_bf16 v[16:31], v[160:163], a[112:115], v[16:31]
    s_waitcnt vmcnt(21)
    s_barrier
    ds_read_b64_tr_b16 v[144:145], v216 offset:8192
    ds_read_b64_tr_b16 v[146:147], v216 offset:9216
    ds_read_b64_tr_b16 v[148:149], v217 offset:8192
    v_mfma_f32_16x16x32_bf16 v[228:231], v[160:163], v[224:227], v[228:231]
    ds_read_b64_tr_b16 v[150:151], v217 offset:9216
    v_mfma_f32_32x32x16_bf16 v[32:47], v[164:167], a[112:115], v[32:47]
    s_add_u32 m0, s3, 2048
    s_add_u32 s0, s101, 655360
    buffer_load_dwordx4 v210, s[40:43], s0 offen lds
    ds_read_b64_tr_b16 v[152:153], v218 offset:8192
    ds_read_b64_tr_b16 v[154:155], v218 offset:9216
    v_mfma_f32_32x32x16_bf16 v[48:63], v[168:171], a[112:115], v[48:63]
    s_add_u32 m0, s3, 3072
    s_add_u32 s0, s101, 663552
    buffer_load_dwordx4 v210, s[40:43], s0 offen lds
    ds_read_b64_tr_b16 v[156:157], v219 offset:8192
    ds_read_b64_tr_b16 v[158:159], v219 offset:9216
    v_mfma_f32_32x32x16_bf16 v[64:79], v[172:175], a[112:115], v[64:79]
    s_waitcnt lgkmcnt(8)
    v_mfma_f32_32x32x16_bf16 v[16:31], v[176:179], a[116:119], v[16:31]
    s_add_u32 m0, s3, 49152
    s_add_u32 s0, s101, 786432
    buffer_load_dwordx4 v210, s[40:43], s0 offen lds
    ds_read_b64_tr_b16 v[160:161], v216 offset:10240
    ds_read_b64_tr_b16 v[162:163], v216 offset:11264
    v_mfma_f32_16x16x32_bf16 v[228:231], v[176:179], v[224:227], v[228:231]
    ds_read_b64_tr_b16 v[164:165], v217 offset:10240
    v_mfma_f32_32x32x16_bf16 v[32:47], v[180:183], a[116:119], v[32:47]
    ds_read_b64_tr_b16 v[166:167], v217 offset:11264
    ds_read_b64_tr_b16 v[168:169], v218 offset:10240
    ds_read_b64_tr_b16 v[170:171], v218 offset:11264
    v_mfma_f32_32x32x16_bf16 v[48:63], v[184:187], a[116:119], v[48:63]
    s_add_u32 m0, s3, 50176
    s_add_u32 s0, s101, 794624
    buffer_load_dwordx4 v210, s[40:43], s0 offen lds
    ds_read_b64_tr_b16 v[172:173], v219 offset:10240
    ds_read_b64_tr_b16 v[174:175], v219 offset:11264
    v_mfma_f32_32x32x16_bf16 v[64:79], v[188:191], a[116:119], v[64:79]
    s_waitcnt lgkmcnt(8)
    v_mfma_f32_32x32x16_bf16 v[16:31], v[144:147], a[120:123], v[16:31]
    s_add_u32 m0, s3, 81920
    ds_read_b64_tr_b16 v[176:177], v216 offset:16384
    buffer_load_dwordx4 v211, s[36:39], s95 offen lds
    ds_read_b64_tr_b16 v[178:179], v216 offset:17408
    ds_read_b64_tr_b16 v[180:181], v217 offset:16384
    v_mfma_f32_16x16x32_bf16 v[228:231], v[144:147], v[224:227], v[228:231]
    ds_read_b64_tr_b16 v[182:183], v217 offset:17408
    v_mfma_f32_32x32x16_bf16 v[32:47], v[148:151], a[120:123], v[32:47]
    ds_read_b64_tr_b16 v[184:185], v218 offset:16384
    ds_read_b64_tr_b16 v[186:187], v218 offset:17408
    ds_read_b64_tr_b16 v[188:189], v219 offset:16384
    v_mfma_f32_32x32x16_bf16 v[48:63], v[152:155], a[120:123], v[48:63]
    s_add_u32 m0, s3, 82944
    ds_read_b64_tr_b16 v[190:191], v219 offset:17408
    buffer_load_dwordx4 v14, s[36:39], s95 offen lds
    v_mfma_f32_32x32x16_bf16 v[64:79], v[156:159], a[120:123], v[64:79]
    s_waitcnt vmcnt(26) lgkmcnt(8)
    v_mfma_f32_32x32x16_bf16 v[16:31], v[160:163], a[124:127], v[16:31]
    s_add_u32 m0, s3, 90112
    ds_read_b64_tr_b16 v[144:145], v216 offset:18432
    buffer_load_dwordx4 v211, s[36:39], s96 offen lds
    ds_read_b64_tr_b16 v[146:147], v216 offset:19456
    ds_read_b64_tr_b16 v[148:149], v217 offset:18432
    v_mfma_f32_16x16x32_bf16 v[228:231], v[160:163], v[224:227], v[228:231]
    ds_read_b64_tr_b16 v[150:151], v217 offset:19456
    v_mfma_f32_32x32x16_bf16 v[32:47], v[164:167], a[124:127], v[32:47]
    ds_read_b64_tr_b16 v[152:153], v218 offset:18432
    ds_read_b64_tr_b16 v[154:155], v218 offset:19456
    ds_read_b64_tr_b16 v[156:157], v219 offset:18432
    v_mfma_f32_32x32x16_bf16 v[48:63], v[168:171], a[124:127], v[48:63]
    s_nop 1
    v_cvt_pk_bf16_f32 v200, v228, v228
    v_cvt_pk_bf16_f32 v201, v229, v229
    v_cvt_pk_bf16_f32 v202, v230, v230
    v_cvt_pk_bf16_f32 v203, v231, v231
    v_lshlrev_b32 v200, 16, v200
    v_lshlrev_b32 v201, 16, v201
    v_lshlrev_b32 v202, 16, v202
    v_lshlrev_b32 v203, 16, v203
    v_mfma_f32_32x32x16_bf16 v[64:79], v[172:175], a[124:127], v[64:79]
    v_sub_f32 v200, v228, v200
    v_sub_f32 v201, v229, v201
    v_sub_f32 v202, v230, v202
    v_sub_f32 v203, v231, v203
    v_cvt_pk_bf16_f32 v200, v228, v200
    v_cvt_pk_bf16_f32 v201, v229, v201
    v_cvt_pk_bf16_f32 v202, v230, v202
    v_cvt_pk_bf16_f32 v203, v231, v203
    s_mov_b32 exec_lo, 0x00030003
    s_mov_b32 exec_hi, 0x00030003
    ds_write_b128 v238, v[200:203] offset:1024
    s_mov_b64 exec, -1
    ds_read_b64_tr_b16 v[158:159], v219 offset:19456
    s_waitcnt lgkmcnt(9)
    v_mfma_f32_32x32x16_bf16 v[80:95], v[176:179], a[0:3], 0
    s_waitcnt vmcnt(23)
    s_barrier
    s_add_u32 m0, s3, 91136
    ds_read_b64_tr_b16 v[160:161], v216 offset:24576
    buffer_load_dwordx4 v14, s[36:39], s96 offen lds
    v_mfma_f32_16x16x32_bf16 v[228:231], v[176:179], v[224:227], 0
    ds_read_b64_tr_b16 v[162:163], v216 offset:25600
    v_mfma_f32_32x32x16_bf16 v[96:111], v[180:183], a[0:3], 0
    s_add_u32 m0, s3, 57344
    s_add_u32 s0, s101, 917504
    buffer_load_dwordx4 v210, s[40:43], s0 offen lds
    ds_read_b64_tr_b16 v[164:165], v217 offset:24576
    ds_read_b64_tr_b16 v[166:167], v217 offset:25600
    v_mfma_f32_32x32x16_bf16 v[112:127], v[184:187], a[0:3], 0
    s_add_u32 m0, s3, 58368
    s_add_u32 s0, s101, 925696
    buffer_load_dwordx4 v210, s[40:43], s0 offen lds
    ds_read_b64_tr_b16 v[168:169], v218 offset:24576
    ds_read_b64_tr_b16 v[170:171], v218 offset:25600
    v_mfma_f32_32x32x16_bf16 v[128:143], v[188:191], a[0:3], 0
    s_waitcnt vmcnt(24) lgkmcnt(7)
    s_barrier
    ds_read2st64_b32 v[192:193], v239 offset0:4 offset1:4
    ds_read_b64_tr_b16 v[172:173], v219 offset:24576
    ds_read_b64_tr_b16 v[174:175], v219 offset:25600
    s_waitcnt lgkmcnt(9)
    v_mfma_f32_32x32x16_bf16 v[80:95], v[144:147], a[4:7], v[80:95]
    v_xor_b32 v10, 64, v239
    ds_read2st64_b32 v[196:197], v10 offset0:4 offset1:4
    ds_read_b64_tr_b16 v[176:177], v216 offset:26624
    ds_read_b64_tr_b16 v[178:179], v216 offset:27648
    ds_read_b64_tr_b16 v[180:181], v217 offset:26624
    v_mfma_f32_16x16x32_bf16 v[228:231], v[144:147], v[224:227], v[228:231]
    ds_read_b64_tr_b16 v[182:183], v217 offset:27648
    v_mfma_f32_32x32x16_bf16 v[96:111], v[148:151], a[4:7], v[96:111]
    s_add_u32 m0, s3, 32768
    s_add_u32 s0, s101, 1048576
    buffer_load_dwordx4 v210, s[40:43], s0 offen lds
    ds_read_b64_tr_b16 v[184:185], v218 offset:26624
    ds_read_b64_tr_b16 v[186:187], v218 offset:27648
    v_mfma_f32_32x32x16_bf16 v[112:127], v[152:155], a[4:7], v[112:127]
    s_add_u32 m0, s3, 33792
    s_add_u32 s0, s101, 1056768
    buffer_load_dwordx4 v210, s[40:43], s0 offen lds
    ds_read_b64_tr_b16 v[188:189], v219 offset:26624
    ds_read_b64_tr_b16 v[190:191], v219 offset:27648
    v_mfma_f32_32x32x16_bf16 v[128:143], v[156:159], a[4:7], v[128:143]
    s_waitcnt lgkmcnt(11)
    v_mfma_f32_32x32x16_bf16 v[16:31], v[192:195], v[232:235], v[16:31]
    v_xor_b32 v10, 128, v239
    ds_read2st64_b32 v[192:193], v10 offset0:4 offset1:4
    s_waitcnt lgkmcnt(10)
    v_mfma_f32_32x32x16_bf16 v[80:95], v[160:163], a[8:11], v[80:95]
    s_add_u32 m0, s3, 98304
    ds_read_b64_tr_b16 v[144:145], v216 offset:32768
    buffer_load_dwordx4 v211, s[36:39], s88 offen lds
    ds_read_b64_tr_b16 v[146:147], v216 offset:33792
    ds_read_b64_tr_b16 v[148:149], v217 offset:32768
    v_mfma_f32_16x16x32_bf16 v[228:231], v[160:163], v[224:227], v[228:231]
    s_waitcnt lgkmcnt(12)
    v_mfma_f32_32x32x16_bf16 v[32:47], v[196:199], v[232:235], v[32:47]
    v_xor_b32 v10, 192, v239
    ds_read2st64_b32 v[196:197], v10 offset0:4 offset1:4
    ds_read_b64_tr_b16 v[150:151], v217 offset:33792
    v_mfma_f32_32x32x16_bf16 v[96:111], v[164:167], a[8:11], v[96:111]
    ds_read_b64_tr_b16 v[152:153], v218 offset:32768
    ds_read_b64_tr_b16 v[154:155], v218 offset:33792
    ds_read_b64_tr_b16 v[156:157], v219 offset:32768
    s_waitcnt lgkmcnt(8)
    v_mfma_f32_32x32x16_bf16 v[48:63], v[192:195], v[232:235], v[48:63]
    ds_read_b64_tr_b16 v[158:159], v219 offset:33792
    v_mfma_f32_32x32x16_bf16 v[112:127], v[168:171], a[8:11], v[112:127]
    s_add_u32 m0, s3, 99328
    s_nop 0
    buffer_load_dwordx4 v14, s[36:39], s88 offen lds
    s_waitcnt vmcnt(20)
    ds_read_b64_tr_b16 a[152:153], v208 offset:10240
    ds_read_b64_tr_b16 a[156:157], v209 offset:10240
    s_waitcnt lgkmcnt(7)
    v_mfma_f32_32x32x16_bf16 v[64:79], v[196:199], v[232:235], v[64:79]
    v_mfma_f32_32x32x16_bf16 v[128:143], v[172:175], a[8:11], v[128:143]
    ds_read_b64_tr_b16 a[154:155], v208 offset:11264
    ds_read_b64_tr_b16 a[158:159], v209 offset:11264
    v_mfma_f32_32x32x16_bf16 v[80:95], v[176:179], a[12:15], v[80:95]
    s_add_u32 m0, s3, 106496
    ds_read_b64_tr_b16 v[160:161], v216 offset:34816
    buffer_load_dwordx4 v211, s[36:39], s89 offen lds
    s_xor_b32 s79, s68, 0
    ds_read_b64_tr_b16 v[162:163], v216 offset:35840
    v_mfma_f32_16x16x32_bf16 v[228:231], v[176:179], v[224:227], v[228:231]
    ds_read_b64_tr_b16 v[164:165], v217 offset:34816
    v_mfma_f32_32x32x16_bf16 v[96:111], v[180:183], a[12:15], v[96:111]
    s_lshl_b32 s79, s79, 10
    s_add_u32 s79, s79, s7
    v_mul_f32 v16, v16, v24
    v_mul_f32 v17, v17, v25
    ds_read_b64_tr_b16 v[166:167], v217 offset:35840
    ds_read_b64_tr_b16 v[168:169], v218 offset:34816
    v_mfma_f32_32x32x16_bf16 v[112:127], v[184:187], a[12:15], v[112:127]
    s_add_u32 m0, s3, 107520
    ds_read_b64_tr_b16 v[170:171], v218 offset:35840
    buffer_load_dwordx4 v14, s[36:39], s89 offen lds
    v_mul_f32 v18, v18, v26
    ds_read_b64_tr_b16 v[172:173], v219 offset:34816
    v_mfma_f32_32x32x16_bf16 v[128:143], v[188:191], a[12:15], v[128:143]
    v_mul_f32 v19, v19, v27
    v_mul_f32 v20, v20, v28
    v_mul_f32 v21, v21, v29
    v_mul_f32 v22, v22, v30
    ds_read_b64_tr_b16 v[174:175], v219 offset:35840
    s_waitcnt lgkmcnt(12)
    v_mfma_f32_32x32x16_bf16 v[80:95], v[144:147], a[16:19], v[80:95]
    s_barrier
    v_mul_f32 v23, v23, v31
    v_cvt_pk_bf16_f32 v24, v16, v17
    s_waitcnt vmcnt(20)
    ds_read_b64_tr_b16 a[160:161], v208 offset:18432
    v_mfma_f32_16x16x32_bf16 v[228:231], v[144:147], v[224:227], v[228:231]
    ds_read_b64_tr_b16 v[176:177], v216 offset:40960
    v_mfma_f32_32x32x16_bf16 v[96:111], v[148:151], a[16:19], v[96:111]
    v_cvt_pk_bf16_f32 v25, v18, v19
    v_cvt_pk_bf16_f32 v26, v20, v21
    ds_read_b64_tr_b16 a[164:165], v209 offset:18432
    ds_read_b64_tr_b16 a[162:163], v208 offset:19456
    ds_read_b64_tr_b16 v[178:179], v216 offset:41984
    v_mfma_f32_32x32x16_bf16 v[112:127], v[152:155], a[16:19], v[112:127]
    v_cvt_pk_bf16_f32 v27, v22, v23
    buffer_store_dwordx4 v[24:27], v1, s[48:51], s79 offen  sc1
    ds_read_b64_tr_b16 v[180:181], v217 offset:40960
    ds_read_b64_tr_b16 v[182:183], v217 offset:41984
    ds_read_b64_tr_b16 v[184:185], v218 offset:40960
    v_mfma_f32_32x32x16_bf16 v[128:143], v[156:159], a[16:19], v[128:143]
    s_xor_b32 s79, s68, 1
    s_lshl_b32 s79, s79, 10
    s_add_u32 s79, s79, s7
    ds_read_b64_tr_b16 v[186:187], v218 offset:41984
    ds_read_b64_tr_b16 v[188:189], v219 offset:40960
    ds_read_b64_tr_b16 v[190:191], v219 offset:41984
    s_waitcnt lgkmcnt(11)
    v_mfma_f32_32x32x16_bf16 v[80:95], v[160:163], a[20:23], v[80:95]
    v_mul_f32 v32, v32, v40
    v_mul_f32 v33, v33, v41
    v_mul_f32 v34, v34, v42
    ds_read_b64_tr_b16 a[166:167], v209 offset:19456
    ds_read_b64_tr_b16 v[144:145], v216 offset:43008
    ds_read_b64_tr_b16 v[146:147], v216 offset:44032
    v_mfma_f32_16x16x32_bf16 v[228:231], v[160:163], v[224:227], v[228:231]
    ds_read_b64_tr_b16 v[148:149], v217 offset:43008
    v_mfma_f32_32x32x16_bf16 v[96:111], v[164:167], a[20:23], v[96:111]
    v_mul_f32 v35, v35, v43
    v_mul_f32 v36, v36, v44
    s_add_u32 m0, s3, 10240
    s_add_u32 s0, s101, 1179648
L_pad_2:
    s_cbranch_execz L_walk_1
    buffer_load_dwordx4 v210, s[40:43], s0 offen lds
    ds_read_b64_tr_b16 v[150:151], v217 offset:44032
    v_mfma_f32_32x32x16_bf16 v[112:127], v[168:171], a[20:23], v[112:127]
    v_mul_f32 v37, v37, v45
    v_mul_f32 v38, v38, v46
    s_add_u32 m0, s3, 11264
    s_add_u32 s0, s101, 1187840
    buffer_load_dwordx4 v210, s[40:43], s0 offen lds
    ds_read_b64_tr_b16 v[152:153], v218 offset:43008
    v_mfma_f32_32x32x16_bf16 v[128:143], v[172:175], a[20:23], v[128:143]
    v_mul_f32 v39, v39, v47
    v_cvt_pk_bf16_f32 v40, v32, v33
    ds_read_b64_tr_b16 v[154:155], v218 offset:44032
    ds_read_b64_tr_b16 v[156:157], v219 offset:43008
    ds_read_b64_tr_b16 v[158:159], v219 offset:44032
    s_waitcnt lgkmcnt(9)
    v_mfma_f32_32x32x16_bf16 v[80:95], v[176:179], a[24:27], v[80:95]
    s_add_u32 m0, s3, 114688
    ds_read_b64_tr_b16 v[160:161], v216 offset:49152
    buffer_load_dwordx4 v211, s[36:39], s90 offen lds
    v_cvt_pk_bf16_f32 v41, v34, v35
    v_cvt_pk_bf16_f32 v42, v36, v37
    s_waitcnt lgkmcnt(9)
    v_mfma_f32_16x16x32_bf16 v[228:231], v[176:179], v[224:227], v[228:231]
    ds_read_b64_tr_b16 v[162:163], v216 offset:50176
    v_mfma_f32_32x32x16_bf16 v[96:111], v[180:183], a[24:27], v[96:111]
    v_cvt_pk_bf16_f32 v43, v38, v39
    buffer_store_dwordx4 v[40:43], v1, s[48:51], s79 offen  sc1
    ds_read_b64_tr_b16 v[164:165], v217 offset:49152
    ds_read_b64_tr_b16 v[166:167], v217 offset:50176
    ds_read_b64_tr_b16 v[168:169], v218 offset:49152
    v_mfma_f32_32x32x16_bf16 v[112:127], v[184:187], a[24:27], v[112:127]
    s_add_u32 m0, s3, 115712
    ds_read_b64_tr_b16 v[170:171], v218 offset:50176
    buffer_load_dwordx4 v14, s[36:39], s90 offen lds
    s_xor_b32 s79, s68, 2
    s_lshl_b32 s79, s79, 10
    ds_read_b64_tr_b16 v[172:173], v219 offset:49152
    v_mfma_f32_32x32x16_bf16 v[128:143], v[188:191], a[24:27], v[128:143]
    s_add_u32 s79, s79, s7
    v_mul_f32 v48, v48, v56
    v_mul_f32 v49, v49, v57
    v_mul_f32 v50, v50, v58
    ds_read_b64_tr_b16 v[174:175], v219 offset:50176
    s_waitcnt lgkmcnt(8)
    v_mfma_f32_32x32x16_bf16 v[80:95], v[144:147], a[28:31], v[80:95]
    s_add_u32 m0, s3, 122880
    ds_read_b64_tr_b16 v[176:177], v216 offset:51200
    buffer_load_dwordx4 v211, s[36:39], s91 offen lds
    v_mul_f32 v51, v51, v59
    v_mul_f32 v52, v52, v60
    ds_read_b64_tr_b16 v[178:179], v216 offset:52224
    v_mfma_f32_16x16x32_bf16 v[228:231], v[144:147], v[224:227], v[228:231]
    ds_read_b64_tr_b16 v[180:181], v217 offset:51200
    v_mfma_f32_32x32x16_bf16 v[96:111], v[148:151], a[28:31], v[96:111]
    v_mul_f32 v53, v53, v61
    v_mul_f32 v54, v54, v62
    s_add_u32 m0, s3, 18432
    s_add_u32 s0, s101, 1310720
    buffer_load_dwordx4 v210, s[40:43], s0 offen lds
    ds_read_b64_tr_b16 v[182:183], v217 offset:52224
    v_mfma_f32_32x32x16_bf16 v[112:127], v[152:155], a[28:31], v[112:127]
    s_add_u32 m0, s3, 123904
    ds_read_b64_tr_b16 v[184:185], v218 offset:51200
    buffer_load_dwordx4 v14, s[36:39], s91 offen lds
    v_mul_f32 v55, v55, v63
    v_cvt_pk_bf16_f32 v56, v48, v49
    ds_read_b64_tr_b16 v[186:187], v218 offset:52224
    v_mfma_f32_32x32x16_bf16 v[128:143], v[156:159], a[28:31], v[128:143]
    v_cvt_pk_bf16_f32 v57, v50, v51
    v_cvt_pk_bf16_f32 v58, v52, v53
    ds_read_b64_tr_b16 v[188:189], v219 offset:51200
    ds_read_b64_tr_b16 v[190:191], v219 offset:52224
    s_waitcnt lgkmcnt(8)
    v_mfma_f32_32x32x16_bf16 v[80:95], v[160:163], a[32:35], v[80:95]
    s_barrier
    v_cvt_pk_bf16_f32 v59, v54, v55
    buffer_store_dwordx4 v[56:59], v1, s[48:51], s79 offen  sc1
    ds_read_b64_tr_b16 v[144:145], v216 offset:57344
    ds_read_b64_tr_b16 v[146:147], v216 offset:58368
    v_mfma_f32_16x16x32_bf16 v[228:231], v[160:163], v[224:227], v[228:231]
    ds_read_b64_tr_b16 v[148:149], v217 offset:57344
    v_mfma_f32_32x32x16_bf16 v[96:111], v[164:167], a[32:35], v[96:111]
    s_xor_b32 s79, s68, 3
    s_lshl_b32 s79, s79, 10
    s_add_u32 s79, s79, s7
    v_mul_f32 v64, v64, v72
    ds_read_b64_tr_b16 v[150:151], v217 offset:58368
    ds_read_b64_tr_b16 v[152:153], v218 offset:57344
    ds_read_b64_tr_b16 v[154:155], v218 offset:58368
    v_mfma_f32_32x32x16_bf16 v[112:127], v[168:171], a[32:35], v[112:127]
    v_mul_f32 v65, v65, v73
    v_mul_f32 v66, v66, v74
    s_add_u32 m0, s3, 19456
    s_add_u32 s0, s101, 1318912
    buffer_load_dwordx4 v210, s[40:43], s0 offen lds
    s_waitcnt vmcnt(25)
    v_mfma_f32_32x32x16_bf16 v[128:143], v[172:175], a[32:35], v[128:143]
    v_mul_f32 v67, v67, v75
    v_mul_f32 v68, v68, v76
    ds_read_b64_tr_b16 a[168:169], v208 offset:2048
    ds_read_b64_tr_b16 v[156:157], v219 offset:57344
    ds_read_b64_tr_b16 v[158:159], v219 offset:58368
    s_waitcnt lgkmcnt(9)
    v_mfma_f32_32x32x16_bf16 v[80:95], v[176:179], a[36:39], v[80:95]
    v_mul_f32 v69, v69, v77
    v_mul_f32 v70, v70, v78
    ds_read_b64_tr_b16 a[172:173], v209 offset:2048
    ds_read_b64_tr_b16 a[170:171], v208 offset:3072
    ds_read_b64_tr_b16 a[174:175], v209 offset:3072
    s_waitcnt vmcnt(23)
    v_mfma_f32_16x16x32_bf16 v[228:231], v[176:179], v[224:227], v[228:231]
    ds_read_b64_tr_b16 v[160:161], v216 offset:59392
    v_mfma_f32_32x32x16_bf16 v[96:111], v[180:183], a[36:39], v[96:111]
    v_mul_f32 v71, v71, v79
    v_cvt_pk_bf16_f32 v72, v64, v65
    v_cvt_pk_bf16_f32 v73, v66, v67
    v_cvt_pk_bf16_f32 v74, v68, v69
    ds_read_b64_tr_b16 a[176:177], v208 offset:49152
    ds_read_b64_tr_b16 a[180:181], v209 offset:49152
    ds_read_b64_tr_b16 v[162:163], v216 offset:60416
    v_mfma_f32_32x32x16_bf16 v[112:127], v[184:187], a[36:39], v[112:127]
    v_cvt_pk_bf16_f32 v75, v70, v71
    buffer_store_dwordx4 v[72:75], v1, s[48:51], s79 offen  sc1
    ds_read_b64_tr_b16 v[164:165], v217 offset:59392
    ds_read_b64_tr_b16 v[166:167], v217 offset:60416
    ds_read_b64_tr_b16 v[168:169], v218 offset:59392
    v_mfma_f32_32x32x16_bf16 v[128:143], v[188:191], a[36:39], v[128:143]
    s_add_u32 s7, s7, 57344
    ds_read_b64_tr_b16 v[170:171], v218 offset:60416
    ds_read_b64_tr_b16 v[172:173], v219 offset:59392
    ds_read_b64_tr_b16 v[174:175], v219 offset:60416
    s_waitcnt lgkmcnt(13)
    v_mfma_f32_32x32x16_bf16 v[80:95], v[144:147], a[40:43], v[80:95]
    s_add_u32 m0, s3, 131072
    ds_read_b64_tr_b16 v[176:177], v212 offset:8192
    buffer_load_dwordx4 v211, s[36:39], s1 offen lds
    ds_read_b64_tr_b16 a[178:179], v208 offset:50176
    ds_read_b64_tr_b16 a[182:183], v209 offset:50176
    s_waitcnt lgkmcnt(13)
    v_mfma_f32_16x16x32_bf16 v[228:231], v[144:147], v[224:227], v[228:231]
    ds_read_b64_tr_b16 v[178:179], v212 offset:9216
    v_mfma_f32_32x32x16_bf16 v[96:111], v[148:151], a[40:43], v[96:111]
    s_add_u32 m0, s3, 2048
    s_add_u32 s0, s101, 1441792
    buffer_load_dwordx4 v210, s[40:43], s0 offen lds
    ds_read_b64_tr_b16 v[180:181], v213 offset:8192
    ds_read_b64_tr_b16 v[182:183], v213 offset:9216
    ds_read_b64_tr_b16 v[184:185], v214 offset:8192
    v_mfma_f32_32x32x16_bf16 v[112:127], v[152:155], a[40:43], v[112:127]
    s_add_u32 m0, s3, 132096
    ds_read_b64_tr_b16 v[186:187], v214 offset:9216
    buffer_load_dwordx4 v14, s[36:39], s1 offen lds
    ds_read_b64_tr_b16 v[188:189], v215 offset:8192
    ds_read_b64_tr_b16 v[190:191], v215 offset:9216
    v_mfma_f32_32x32x16_bf16 v[128:143], v[156:159], a[40:43], v[128:143]
    s_add_u32 m0, s3, 3072
    s_add_u32 s0, s101, 1449984
    buffer_load_dwordx4 v210, s[40:43], s0 offen lds
    s_waitcnt lgkmcnt(7)
    v_mfma_f32_32x32x16_bf16 v[80:95], v[160:163], a[44:47], v[80:95]
    s_add_u32 m0, s3, 49152
    s_add_u32 s0, s101, 1572864
    buffer_load_dwordx4 v210, s[40:43], s0 offen lds
    ds_read_b64_tr_b16 v[144:145], v212 offset:10240
    ds_read_b64_tr_b16 v[146:147], v212 offset:11264
    ds_read_b64_tr_b16 v[148:149], v213 offset:10240
    v_mfma_f32_16x16x32_bf16 v[228:231], v[160:163], v[224:227], v[228:231]
    ds_read_b64_tr_b16 v[150:151], v213 offset:11264
    v_mfma_f32_32x32x16_bf16 v[96:111], v[164:167], a[44:47], v[96:111]
    s_add_u32 m0, s3, 50176
    s_add_u32 s0, s101, 1581056
    buffer_load_dwordx4 v210, s[40:43], s0 offen lds
    s_waitcnt vmcnt(24)
    ds_read_b64_tr_b16 a[184:185], v208 offset:57344
    ds_read_b64_tr_b16 a[188:189], v209 offset:57344
    v_mfma_f32_32x32x16_bf16 v[112:127], v[168:171], a[44:47], v[112:127]
    ds_read_b64_tr_b16 a[186:187], v208 offset:58368
    ds_read_b64_tr_b16 a[190:191], v209 offset:58368
    ds_read_b64_tr_b16 v[152:153], v214 offset:10240
    v_mfma_f32_32x32x16_bf16 v[128:143], v[172:175], a[44:47], v[128:143]
    ds_read_b64_tr_b16 v[154:155], v214 offset:11264
    ds_read_b64_tr_b16 v[156:157], v215 offset:10240
    ds_read_b64_tr_b16 v[158:159], v215 offset:11264
    s_waitcnt lgkmcnt(12)
    v_mfma_f32_32x32x16_bf16 v[80:95], v[176:179], a[48:51], v[80:95]
    s_barrier
    ds_read_b64_tr_b16 v[160:161], v212 offset:32768
    ds_read_b64_tr_b16 v[162:163], v212 offset:33792
    ds_read_b64_tr_b16 v[164:165], v213 offset:32768
    v_mfma_f32_16x16x32_bf16 v[228:231], v[176:179], v[224:227], v[228:231]
    ds_read_b64_tr_b16 v[166:167], v213 offset:33792
    v_mfma_f32_32x32x16_bf16 v[96:111], v[180:183], a[48:51], v[96:111]
    s_waitcnt lgkmcnt(8)
    s_add_u32 m0, s3, 57344
    s_add_u32 s0, s101, 1703936
    buffer_load_dwordx4 v210, s[40:43], s0 offen lds
    s_waitcnt vmcnt(23)
    ds_read_b64_tr_b16 a[192:193], v208 offset:32768
    v_mfma_f32_32x32x16_bf16 v[112:127], v[184:187], a[48:51], v[112:127]
    ds_read_b64_tr_b16 a[196:197], v209 offset:32768
    ds_read_b64_tr_b16 a[194:195], v208 offset:33792
    ds_read_b64_tr_b16 v[168:169], v214 offset:32768
    v_mfma_f32_32x32x16_bf16 v[128:143], v[188:191], a[48:51], v[128:143]
    ds_read_b64_tr_b16 v[170:171], v214 offset:33792
    ds_read_b64_tr_b16 v[172:173], v215 offset:32768
    ds_read_b64_tr_b16 v[174:175], v215 offset:33792
    s_waitcnt lgkmcnt(11)
    v_mfma_f32_32x32x16_bf16 v[80:95], v[144:147], a[52:55], v[80:95]
    ds_read_b64_tr_b16 a[198:199], v209 offset:33792
    s_add_u32 m0, s3, 58368
    s_add_u32 s0, s101, 1712128
    buffer_load_dwordx4 v210, s[40:43], s0 offen lds
    ds_read_b64_tr_b16 v[176:177], v212 offset:34816
    ds_read_b64_tr_b16 v[178:179], v212 offset:35840
    v_mfma_f32_16x16x32_bf16 v[228:231], v[144:147], v[224:227], v[228:231]
    ds_read_b64_tr_b16 v[180:181], v213 offset:34816
    v_mfma_f32_32x32x16_bf16 v[96:111], v[148:151], a[52:55], v[96:111]
    ds_read_b64_tr_b16 v[182:183], v213 offset:35840
    ds_read_b64_tr_b16 v[184:185], v214 offset:34816
    ds_read_b64_tr_b16 v[186:187], v214 offset:35840
    v_mfma_f32_32x32x16_bf16 v[112:127], v[152:155], a[52:55], v[112:127]
    ds_read_b64_tr_b16 v[188:189], v215 offset:34816
    ds_read_b64_tr_b16 v[190:191], v215 offset:35840
    v_mfma_f32_32x32x16_bf16 v[128:143], v[156:159], a[52:55], v[128:143]
    s_waitcnt lgkmcnt(8)
    s_add_u32 m0, s3, 32768
    s_add_u32 s0, s101, 65536
    buffer_load_dwordx4 v210, s[40:43], s0 offen lds
    v_mfma_f32_32x32x16_bf16 v[80:95], v[160:163], a[56:59], v[80:95]
    s_add_u32 m0, s3, 33792
    s_add_u32 s0, s101, 73728
    buffer_load_dwordx4 v210, s[40:43], s0 offen lds
    ds_read_b64_tr_b16 v[144:145], v212 offset:40960
    ds_read_b64_tr_b16 v[146:147], v212 offset:41984
    ds_read_b64_tr_b16 v[148:149], v213 offset:40960
    v_mfma_f32_16x16x32_bf16 v[228:231], v[160:163], v[224:227], v[228:231]
    ds_read_b64_tr_b16 v[150:151], v213 offset:41984
    v_mfma_f32_32x32x16_bf16 v[96:111], v[164:167], a[56:59], v[96:111]
    ds_read_b64_tr_b16 v[152:153], v214 offset:40960
    ds_read_b64_tr_b16 v[154:155], v214 offset:41984
    ds_read_b64_tr_b16 v[156:157], v215 offset:40960
    v_mfma_f32_32x32x16_bf16 v[112:127], v[168:171], a[56:59], v[112:127]
    ds_read_b64_tr_b16 v[158:159], v215 offset:41984
    v_mfma_f32_32x32x16_bf16 v[128:143], v[172:175], a[56:59], v[128:143]
    s_waitcnt lgkmcnt(8)
    v_mfma_f32_32x32x16_bf16 v[80:95], v[176:179], a[60:63], v[80:95]
    ds_read_b64_tr_b16 v[160:161], v212 offset:43008
    ds_read_b64_tr_b16 v[162:163], v212 offset:44032
    ds_read_b64_tr_b16 v[164:165], v213 offset:43008
    v_mfma_f32_16x16x32_bf16 v[228:231], v[176:179], v[224:227], v[228:231]
    ds_read_b64_tr_b16 v[166:167], v213 offset:44032
    v_mfma_f32_32x32x16_bf16 v[96:111], v[180:183], a[60:63], v[96:111]
    ds_read_b64_tr_b16 v[168:169], v214 offset:43008
    ds_read_b64_tr_b16 v[170:171], v214 offset:44032
    ds_read_b64_tr_b16 v[172:173], v215 offset:43008
    v_mfma_f32_32x32x16_bf16 v[112:127], v[184:187], a[60:63], v[112:127]
    s_waitcnt vmcnt(19)
    ds_read_b64_tr_b16 a[200:201], v208 offset:10240
    ds_read_b64_tr_b16 a[204:205], v209 offset:10240
    ds_read_b64_tr_b16 a[202:203], v208 offset:11264
    v_mfma_f32_32x32x16_bf16 v[128:143], v[188:191], a[60:63], v[128:143]
    ds_read_b64_tr_b16 a[206:207], v209 offset:11264
    ds_read_b64_tr_b16 v[174:175], v215 offset:44032
    s_waitcnt lgkmcnt(12)
    v_mfma_f32_32x32x16_bf16 v[80:95], v[144:147], a[64:67], v[80:95]
    s_barrier
    ds_read_b64_tr_b16 v[176:177], v212 offset:49152
    ds_read_b64_tr_b16 v[178:179], v212 offset:50176
    ds_read_b64_tr_b16 v[180:181], v213 offset:49152
    v_mfma_f32_16x16x32_bf16 v[228:231], v[144:147], v[224:227], v[228:231]
    ds_read_b64_tr_b16 v[182:183], v213 offset:50176
    v_mfma_f32_32x32x16_bf16 v[96:111], v[148:151], a[64:67], v[96:111]
    ds_read_b64_tr_b16 v[184:185], v214 offset:49152
    ds_read_b64_tr_b16 v[186:187], v214 offset:50176
    ds_read_b64_tr_b16 v[188:189], v215 offset:49152
    v_mfma_f32_32x32x16_bf16 v[112:127], v[152:155], a[64:67], v[112:127]
    s_waitcnt lgkmcnt(8)
    s_add_u32 m0, s3, 10240
    s_add_u32 s0, s101, 196608
    buffer_load_dwordx4 v210, s[40:43], s0 offen lds
    ds_read_b64_tr_b16 v[190:191], v215 offset:50176
    v_mfma_f32_32x32x16_bf16 v[128:143], v[156:159], a[64:67], v[128:143]
    s_waitcnt vmcnt(11)
    s_waitcnt lgkmcnt(8)
    v_mfma_f32_32x32x16_bf16 v[80:95], v[160:163], a[68:71], v[80:95]
    v_mov_b32 v12, 1
    s_mov_b64 exec, 1
    buffer_store_dword v12, v11, s[52:55], s74 offen offset:512
    buffer_store_dword v12, v11, s[56:59], s74 offen offset:512 sc1
    s_mov_b64 exec, -1
    v_mfma_f32_16x16x32_bf16 v[228:231], v[160:163], v[224:227], v[228:231]
    ds_read_b64_tr_b16 v[144:145], v212 offset:51200
    v_mfma_f32_32x32x16_bf16 v[96:111], v[164:167], a[68:71], v[96:111]
    ds_read_b64_tr_b16 v[146:147], v212 offset:52224
    ds_read_b64_tr_b16 v[148:149], v213 offset:51200
    ds_read_b64_tr_b16 v[150:151], v213 offset:52224
    v_mfma_f32_32x32x16_bf16 v[112:127], v[168:171], a[68:71], v[112:127]
    ds_read_b64_tr_b16 v[152:153], v214 offset:51200
    ds_read_b64_tr_b16 v[154:155], v214 offset:52224
    ds_read_b64_tr_b16 v[156:157], v215 offset:51200
    v_mfma_f32_32x32x16_bf16 v[128:143], v[172:175], a[68:71], v[128:143]
    ds_read_b64_tr_b16 v[158:159], v215 offset:52224
    s_waitcnt lgkmcnt(8)
    v_mfma_f32_32x32x16_bf16 v[80:95], v[176:179], a[72:75], v[80:95]
    ds_read_b64_tr_b16 v[160:161], v212 offset:57344
    ds_read_b64_tr_b16 v[162:163], v212 offset:58368
    ds_read_b64_tr_b16 v[164:165], v213 offset:57344
    v_mfma_f32_16x16x32_bf16 v[228:231], v[176:179], v[224:227], v[228:231]
    ds_read_b64_tr_b16 v[166:167], v213 offset:58368
    v_mfma_f32_32x32x16_bf16 v[96:111], v[180:183], a[72:75], v[96:111]
    ds_read_b64_tr_b16 v[168:169], v214 offset:57344
    ds_read_b64_tr_b16 v[170:171], v214 offset:58368
    ds_read_b64_tr_b16 v[172:173], v215 offset:57344
    v_mfma_f32_32x32x16_bf16 v[112:127], v[184:187], a[72:75], v[112:127]
    ds_read_b64_tr_b16 a[208:209], v208 offset:18432
    ds_read_b64_tr_b16 a[212:213], v209 offset:18432
    ds_read_b64_tr_b16 a[210:211], v208 offset:19456
    v_mfma_f32_32x32x16_bf16 v[128:143], v[188:191], a[72:75], v[128:143]
    ds_read_b64_tr_b16 a[214:215], v209 offset:19456
    s_add_u32 m0, s3, 11264
    s_add_u32 s0, s101, 204800
    buffer_load_dwordx4 v210, s[40:43], s0 offen lds
    ds_read_b64_tr_b16 v[174:175], v215 offset:58368
    s_waitcnt lgkmcnt(12)
    v_mfma_f32_32x32x16_bf16 v[80:95], v[144:147], a[76:79], v[80:95]
    ds_read_b64_tr_b16 v[176:177], v212 offset:59392
    ds_read_b64_tr_b16 v[178:179], v212 offset:60416
    ds_read_b64_tr_b16 v[180:181], v213 offset:59392
    v_mfma_f32_16x16x32_bf16 v[228:231], v[144:147], v[224:227], v[228:231]
    ds_read_b64_tr_b16 v[182:183], v213 offset:60416
    v_mfma_f32_32x32x16_bf16 v[96:111], v[148:151], a[76:79], v[96:111]
    ds_read_b64_tr_b16 v[184:185], v214 offset:59392
    ds_read_b64_tr_b16 v[186:187], v214 offset:60416
    ds_read_b64_tr_b16 v[188:189], v215 offset:59392
    v_mfma_f32_32x32x16_bf16 v[112:127], v[152:155], a[76:79], v[112:127]
    s_waitcnt lgkmcnt(8)
    s_add_u32 m0, s3, 18432
    s_add_u32 s0, s101, 327680
    buffer_load_dwordx4 v210, s[40:43], s0 offen lds
    ds_read_b64_tr_b16 v[190:191], v215 offset:60416
    v_mfma_f32_32x32x16_bf16 v[128:143], v[156:159], a[76:79], v[128:143]
    s_add_u32 m0, s3, 19456
    s_add_u32 s0, s101, 335872
    buffer_load_dwordx4 v210, s[40:43], s0 offen lds
    s_waitcnt lgkmcnt(8)
    v_mfma_f32_32x32x16_bf16 v[80:95], v[160:163], a[80:83], v[80:95]
    s_barrier
    s_add_u32 m0, s3, 40960
    s_add_u32 s0, s101, 458752
    buffer_load_dwordx4 v210, s[40:43], s0 offen lds
    ds_read_b64_tr_b16 v[144:145], v216 offset:0
    v_mfma_f32_16x16x32_bf16 v[228:231], v[160:163], v[224:227], v[228:231]
    ds_read_b64_tr_b16 v[146:147], v216 offset:1024
    v_mfma_f32_32x32x16_bf16 v[96:111], v[164:167], a[80:83], v[96:111]
    s_add_u32 m0, s3, 41984
    s_add_u32 s0, s101, 466944
    buffer_load_dwordx4 v210, s[40:43], s0 offen lds
    ds_read_b64_tr_b16 v[148:149], v217 offset:0
    ds_read_b64_tr_b16 v[150:151], v217 offset:1024
    ds_read_b64_tr_b16 v[152:153], v218 offset:0
    v_mfma_f32_32x32x16_bf16 v[112:127], v[168:171], a[80:83], v[112:127]
    ds_read_b64_tr_b16 v[154:155], v218 offset:1024
    ds_read_b64_tr_b16 v[156:157], v219 offset:0
    ds_read_b64_tr_b16 v[158:159], v219 offset:1024
    v_mfma_f32_32x32x16_bf16 v[128:143], v[172:175], a[80:83], v[128:143]
    s_waitcnt vmcnt(14)
    ds_read_b64_tr_b16 a[216:217], v208 offset:2048
    ds_read_b64_tr_b16 a[220:221], v209 offset:2048
    ds_read_b64_tr_b16 a[218:219], v208 offset:3072
    s_waitcnt lgkmcnt(11)
    v_mfma_f32_32x32x16_bf16 v[80:95], v[176:179], a[84:87], v[80:95]
    ds_read_b64_tr_b16 a[222:223], v209 offset:3072
    ds_read_b64_tr_b16 v[160:161], v216 offset:2048
    ds_read_b64_tr_b16 v[162:163], v216 offset:3072
    v_mfma_f32_16x16x32_bf16 v[228:231], v[176:179], v[224:227], v[228:231]
    ds_read_b64_tr_b16 v[164:165], v217 offset:2048
    v_mfma_f32_32x32x16_bf16 v[96:111], v[180:183], a[84:87], v[96:111]
    ds_read_b64_tr_b16 v[166:167], v217 offset:3072
    ds_read_b64_tr_b16 v[168:169], v218 offset:2048
    ds_read_b64_tr_b16 v[170:171], v218 offset:3072
    v_mfma_f32_32x32x16_bf16 v[112:127], v[184:187], a[84:87], v[112:127]
    ds_read_b64_tr_b16 v[172:173], v219 offset:2048
    ds_read_b64_tr_b16 v[174:175], v219 offset:3072
    v_mfma_f32_32x32x16_bf16 v[128:143], v[188:191], a[84:87], v[128:143]
    s_mul_i32 s86, s71, 224
    s_add_u32 s86, s86, s68
    s_lshl_b32 s86, s86, 10
    s_add_u32 s86, s86, 4194304
    s_mul_i32 s85, s12, 114688
    s_add_u32 s11, s86, s85
    s_waitcnt lgkmcnt(12)
    v_mfma_f32_32x32x16_bf16 v[80:95], v[144:147], a[88:91], v[80:95]
    s_sub_u32 s10, s86, s85
    s_add_u32 s10, s10, 114688
    buffer_load_dword v12, v223, s[48:51], s74 offen offset:512 sc1
    s_waitcnt lgkmcnt(8)
    ds_read_b64_tr_b16 v[176:177], v216 offset:8192
    ds_read_b64_tr_b16 v[178:179], v216 offset:9216
    v_mfma_f32_16x16x32_bf16 v[228:231], v[144:147], v[224:227], v[228:231]
    ds_read_b64_tr_b16 v[180:181], v217 offset:8192
    v_mfma_f32_32x32x16_bf16 v[96:111], v[148:151], a[88:91], v[96:111]
    s_add_u32 m0, s3, 2048
    s_add_u32 s0, s101, 589824
    buffer_load_dwordx4 v210, s[40:43], s0 offen lds
    s_waitcnt vmcnt(14)
    ds_read_b64_tr_b16 a[224:225], v208 offset:49152
    ds_read_b64_tr_b16 a[228:229], v209 offset:49152
    v_mfma_f32_32x32x16_bf16 v[112:127], v[152:155], a[88:91], v[112:127]
    ds_read_b64_tr_b16 a[226:227], v208 offset:50176
    ds_read_b64_tr_b16 v[182:183], v217 offset:9216
    ds_read_b64_tr_b16 v[184:185], v218 offset:8192
    v_mfma_f32_32x32x16_bf16 v[128:143], v[156:159], a[88:91], v[128:143]
    ds_read_b64_tr_b16 v[186:187], v218 offset:9216
    ds_read_b64_tr_b16 v[188:189], v219 offset:8192
    ds_read_b64_tr_b16 v[190:191], v219 offset:9216
    s_waitcnt lgkmcnt(11)
    v_mfma_f32_32x32x16_bf16 v[80:95], v[160:163], a[92:95], v[80:95]
    ds_read_b64_tr_b16 a[230:231], v209 offset:50176
    s_add_u32 m0, s3, 3072
    s_add_u32 s0, s101, 598016
    buffer_load_dwordx4 v210, s[40:43], s0 offen lds
    ds_read_b64_tr_b16 v[144:145], v216 offset:10240
    ds_read_b64_tr_b16 v[146:147], v216 offset:11264
    v_mfma_f32_16x16x32_bf16 v[228:231], v[160:163], v[224:227], v[228:231]
    ds_read_b64_tr_b16 v[148:149], v217 offset:10240
    v_mfma_f32_32x32x16_bf16 v[96:111], v[164:167], a[92:95], v[96:111]
    ds_read_b64_tr_b16 v[150:151], v217 offset:11264
    ds_read_b64_tr_b16 v[152:153], v218 offset:10240
    ds_read_b64_tr_b16 v[154:155], v218 offset:11264
    v_mfma_f32_32x32x16_bf16 v[112:127], v[168:171], a[92:95], v[112:127]
    ds_read_b64_tr_b16 v[156:157], v219 offset:10240
    ds_read_b64_tr_b16 v[158:159], v219 offset:11264
    v_mfma_f32_32x32x16_bf16 v[128:143], v[172:175], a[92:95], v[128:143]
    s_waitcnt lgkmcnt(8)
    s_add_u32 m0, s3, 49152
    s_add_u32 s0, s101, 720896
    buffer_load_dwordx4 v210, s[40:43], s0 offen lds
    v_mfma_f32_32x32x16_bf16 v[80:95], v[176:179], a[96:99], v[80:95]
    s_barrier
    s_add_u32 m0, s3, 50176
    s_add_u32 s0, s101, 729088
    buffer_load_dwordx4 v210, s[40:43], s0 offen lds
    s_waitcnt vmcnt(15)
    v_mfma_f32_16x16x32_bf16 v[228:231], v[176:179], v[224:227], v[228:231]
    ds_read_b64_tr_b16 v[160:161], v216 offset:16384
    v_mfma_f32_32x32x16_bf16 v[96:111], v[180:183], a[96:99], v[96:111]
    ds_read_b64_tr_b16 a[232:233], v208 offset:57344
    ds_read_b64_tr_b16 a[236:237], v209 offset:57344
    ds_read_b64_tr_b16 v[162:163], v216 offset:17408
    v_mfma_f32_32x32x16_bf16 v[112:127], v[184:187], a[96:99], v[112:127]
    ds_read_b64_tr_b16 v[164:165], v217 offset:16384
    ds_read_b64_tr_b16 v[166:167], v217 offset:17408
    ds_read_b64_tr_b16 v[168:169], v218 offset:16384
    v_mfma_f32_32x32x16_bf16 v[128:143], v[188:191], a[96:99], v[128:143]
    ds_read_b64_tr_b16 v[170:171], v218 offset:17408
    ds_read_b64_tr_b16 v[172:173], v219 offset:16384
    ds_read_b64_tr_b16 v[174:175], v219 offset:17408
    s_waitcnt lgkmcnt(10)
    v_mfma_f32_32x32x16_bf16 v[80:95], v[144:147], a[100:103], v[80:95]
    ds_read_b64_tr_b16 a[234:235], v208 offset:58368
    ds_read_b64_tr_b16 a[238:239], v209 offset:58368
    ds_read_b64_tr_b16 v[176:177], v216 offset:18432
    v_mfma_f32_16x16x32_bf16 v[228:231], v[144:147], v[224:227], v[228:231]
    ds_read_b64_tr_b16 v[178:179], v216 offset:19456
    v_mfma_f32_32x32x16_bf16 v[96:111], v[148:151], a[100:103], v[96:111]
    s_waitcnt vmcnt(4)
    s_mov_b32 s84, 0
L_spine_29:
    v_cmp_gt_u32 vcc, 1, v12
    s_add_u32 s84, s84, 1
    s_cbranch_vccz L_donee_30
    buffer_load_dword v12, v223, s[48:51], s74 offen offset:512 sc1
    s_cmp_ge_u32 s84, 400000
    s_waitcnt vmcnt(0)
    s_cbranch_scc0 L_spine_29
L_donee_30:
    ds_read_b64_tr_b16 v[180:181], v217 offset:18432
    ds_read_b64_tr_b16 v[182:183], v217 offset:19456
    v_mfma_f32_32x32x16_bf16 v[112:127], v[152:155], a[100:103], v[112:127]
    s_add_u32 s85, s10, 0
    buffer_load_dwordx4 a[0:3], v1, s[48:51], s85 offen sc1
    ds_read_b64_tr_b16 v[184:185], v218 offset:18432
    ds_read_b64_tr_b16 v[186:187], v218 offset:19456
    ds_read_b64_tr_b16 v[188:189], v219 offset:18432
    v_mfma_f32_32x32x16_bf16 v[128:143], v[156:159], a[100:103], v[128:143]
    s_waitcnt lgkmcnt(7)
    s_add_u32 m0, s3, 57344
    s_add_u32 s0, s101, 851968
    buffer_load_dwordx4 v210, s[40:43], s0 offen lds
    ds_read_b64_tr_b16 v[190:191], v219 offset:19456
    v_mfma_f32_32x32x16_bf16 v[80:95], v[160:163], a[104:107], v[80:95]
    s_add_u32 s85, s11, 0
    buffer_load_dwordx4 a[4:7], v1, s[48:51], s85 offen sc1
    ds_read_b64_tr_b16 a[240:241], v208 offset:32768
    ds_read_b64_tr_b16 a[244:245], v209 offset:32768
    ds_read_b64_tr_b16 a[242:243], v208 offset:33792
    v_mfma_f32_16x16x32_bf16 v[228:231], v[160:163], v[224:227], v[228:231]
    ds_read_b64_tr_b16 v[144:145], v216 offset:24576
    v_mfma_f32_32x32x16_bf16 v[96:111], v[164:167], a[104:107], v[96:111]
    ds_read_b64_tr_b16 a[246:247], v209 offset:33792
    s_add_u32 m0, s3, 58368
    s_add_u32 s0, s101, 860160
    buffer_load_dwordx4 v210, s[40:43], s0 offen lds
    ds_read_b64_tr_b16 v[146:147], v216 offset:25600
    ds_read_b64_tr_b16 v[148:149], v217 offset:24576
    v_mfma_f32_32x32x16_bf16 v[112:127], v[168:171], a[104:107], v[112:127]
    s_add_u32 s85, s10, 4096
    buffer_load_dwordx4 a[8:11], v1, s[48:51], s85 offen sc1
    ds_read_b64_tr_b16 v[150:151], v217 offset:25600
    ds_read_b64_tr_b16 v[152:153], v218 offset:24576
    ds_read_b64_tr_b16 v[154:155], v218 offset:25600
    v_mfma_f32_32x32x16_bf16 v[128:143], v[172:175], a[104:107], v[128:143]
    ds_read_b64_tr_b16 v[156:157], v219 offset:24576
    ds_read_b64_tr_b16 v[158:159], v219 offset:25600
    s_waitcnt lgkmcnt(12)
    v_mfma_f32_32x32x16_bf16 v[80:95], v[176:179], a[108:111], v[80:95]
    s_add_u32 s85, s11, 4096
    buffer_load_dwordx4 a[12:15], v1, s[48:51], s85 offen sc1
    s_waitcnt lgkmcnt(7)
    ds_read_b64_tr_b16 v[160:161], v216 offset:26624
    ds_read_b64_tr_b16 v[162:163], v216 offset:27648
    ds_read_b64_tr_b16 v[164:165], v217 offset:26624
    v_mfma_f32_16x16x32_bf16 v[228:231], v[176:179], v[224:227], v[228:231]
    ds_read_b64_tr_b16 v[166:167], v217 offset:27648
    v_mfma_f32_32x32x16_bf16 v[96:111], v[180:183], a[108:111], v[96:111]
    s_add_u32 m0, s3, 32768
    s_add_u32 s0, s101, 983040
    buffer_load_dwordx4 v210, s[40:43], s0 offen lds
    ds_read_b64_tr_b16 v[168:169], v218 offset:26624
    ds_read_b64_tr_b16 v[170:171], v218 offset:27648
    ds_read_b64_tr_b16 v[172:173], v219 offset:26624
    v_mfma_f32_32x32x16_bf16 v[112:127], v[184:187], a[108:111], v[112:127]
    s_add_u32 s85, s10, 8192
    buffer_load_dwordx4 a[16:19], v1, s[48:51], s85 offen sc1
    ds_read_b64_tr_b16 v[174:175], v219 offset:27648
    v_mfma_f32_32x32x16_bf16 v[128:143], v[188:191], a[108:111], v[128:143]
    s_add_u32 m0, s3, 33792
    s_add_u32 s0, s101, 991232
    buffer_load_dwordx4 v210, s[40:43], s0 offen lds
    s_waitcnt lgkmcnt(8)
    v_mfma_f32_32x32x16_bf16 v[80:95], v[144:147], a[112:115], v[80:95]
    s_barrier
    s_add_u32 s85, s11, 8192
    buffer_load_dwordx4 a[20:23], v1, s[48:51], s85 offen sc1
    ds_read_b64_tr_b16 v[176:177], v216 offset:32768
    ds_read_b64_tr_b16 v[178:179], v216 offset:33792
    v_mfma_f32_16x16x32_bf16 v[228:231], v[144:147], v[224:227], v[228:231]
    ds_read_b64_tr_b16 v[180:181], v217 offset:32768
    v_mfma_f32_32x32x16_bf16 v[96:111], v[148:151], a[112:115], v[96:111]
    ds_read_b64_tr_b16 v[182:183], v217 offset:33792
    ds_read_b64_tr_b16 v[184:185], v218 offset:32768
    ds_read_b64_tr_b16 v[186:187], v218 offset:33792
    v_mfma_f32_32x32x16_bf16 v[112:127], v[152:155], a[112:115], v[112:127]
    s_add_u32 s85, s10, 12288
    buffer_load_dwordx4 a[24:27], v1, s[48:51], s85 offen sc1
    ds_read_b64_tr_b16 v[188:189], v219 offset:32768
L_pad_3:
    s_cbranch_execz L_pad_4
    ds_read_b64_tr_b16 v[190:191], v219 offset:33792
    v_mfma_f32_32x32x16_bf16 v[128:143], v[156:159], a[112:115], v[128:143]
    ds_read_b64_tr_b16 a[248:249], v208 offset:10240
    ds_read_b64_tr_b16 a[252:253], v209 offset:10240
    ds_read_b64_tr_b16 a[250:251], v208 offset:11264
    s_waitcnt lgkmcnt(11)
    v_mfma_f32_32x32x16_bf16 v[80:95], v[160:163], a[116:119], v[80:95]
    s_add_u32 s85, s11, 12288
    buffer_load_dwordx4 a[28:31], v1, s[48:51], s85 offen sc1
    ds_read_b64_tr_b16 a[254:255], v209 offset:11264
    ds_read_b64_tr_b16 v[144:145], v216 offset:34816
    ds_read_b64_tr_b16 v[146:147], v216 offset:35840
    v_mfma_f32_16x16x32_bf16 v[228:231], v[160:163], v[224:227], v[228:231]
    ds_read_b64_tr_b16 v[148:149], v217 offset:34816
    v_mfma_f32_32x32x16_bf16 v[96:111], v[164:167], a[116:119], v[96:111]
    ds_read_b64_tr_b16 v[150:151], v217 offset:35840
    ds_read_b64_tr_b16 v[152:153], v218 offset:34816
    ds_read_b64_tr_b16 v[154:155], v218 offset:35840
    v_mfma_f32_32x32x16_bf16 v[112:127], v[168:171], a[116:119], v[112:127]
    s_add_u32 s85, s10, 16384
    buffer_load_dwordx4 a[32:35], v1, s[48:51], s85 offen sc1
    ds_read_b64_tr_b16 v[156:157], v219 offset:34816
    ds_read_b64_tr_b16 v[158:159], v219 offset:35840
    v_mfma_f32_32x32x16_bf16 v[128:143], v[172:175], a[116:119], v[128:143]
    s_waitcnt lgkmcnt(8)
    s_add_u32 m0, s3, 10240
    s_add_u32 s0, s101, 1114112
    buffer_load_dwordx4 v210, s[40:43], s0 offen lds
    v_mfma_f32_32x32x16_bf16 v[80:95], v[176:179], a[120:123], v[80:95]
    s_add_u32 s85, s11, 16384
    buffer_load_dwordx4 a[36:39], v1, s[48:51], s85 offen sc1
    ds_read_b64_tr_b16 v[240:241], v208 offset:18432
    ds_read_b64_tr_b16 v[244:245], v209 offset:18432
    ds_read_b64_tr_b16 v[242:243], v208 offset:19456
    v_mfma_f32_16x16x32_bf16 v[228:231], v[176:179], v[224:227], v[228:231]
    v_mfma_f32_32x32x16_bf16 v[96:111], v[180:183], a[120:123], v[96:111]
    ds_read_b64_tr_b16 v[246:247], v209 offset:19456
    s_add_u32 m0, s3, 11264
    s_add_u32 s0, s101, 1122304
    buffer_load_dwordx4 v210, s[40:43], s0 offen lds
    v_mfma_f32_32x32x16_bf16 v[112:127], v[184:187], a[120:123], v[112:127]
    s_add_u32 s85, s10, 20480
    buffer_load_dwordx4 a[40:43], v1, s[48:51], s85 offen sc1
    v_mfma_f32_32x32x16_bf16 v[128:143], v[188:191], a[120:123], v[128:143]
    s_waitcnt lgkmcnt(4)
    v_mfma_f32_32x32x16_bf16 v[80:95], v[144:147], a[124:127], v[80:95]
    s_add_u32 s85, s11, 20480
    buffer_load_dwordx4 a[44:47], v1, s[48:51], s85 offen sc1
    s_waitcnt lgkmcnt(0)
    v_mfma_f32_16x16x32_bf16 v[228:231], v[144:147], v[224:227], v[228:231]
    v_mfma_f32_32x32x16_bf16 v[96:111], v[148:151], a[124:127], v[96:111]
    s_add_u32 m0, s3, 18432
    s_add_u32 s0, s101, 1245184
    buffer_load_dwordx4 v210, s[40:43], s0 offen lds
    ds_read_b64_tr_b16 v[248:249], v208 offset:40960
    ds_read_b64_tr_b16 v[252:253], v209 offset:40960
    v_mfma_f32_32x32x16_bf16 v[112:127], v[152:155], a[124:127], v[112:127]
    s_nop 0
    v_cvt_pk_bf16_f32 v200, v228, v228
    v_cvt_pk_bf16_f32 v201, v229, v229
    v_cvt_pk_bf16_f32 v202, v230, v230
    v_cvt_pk_bf16_f32 v203, v231, v231
    v_lshlrev_b32 v200, 16, v200
    v_lshlrev_b32 v201, 16, v201
    v_lshlrev_b32 v202, 16, v202
    v_lshlrev_b32 v203, 16, v203
    v_mfma_f32_32x32x16_bf16 v[128:143], v[156:159], a[124:127], v[128:143]
    v_sub_f32 v200, v228, v200
    v_sub_f32 v201, v229, v201
    v_sub_f32 v202, v230, v202
    v_sub_f32 v203, v231, v203
    v_cvt_pk_bf16_f32 v200, v228, v200
    v_cvt_pk_bf16_f32 v201, v229, v201
    v_cvt_pk_bf16_f32 v202, v230, v202
    v_cvt_pk_bf16_f32 v203, v231, v203
    s_mov_b32 exec_lo, 0x00030003
    s_mov_b32 exec_hi, 0x00030003
    ds_write_b128 v238, v[200:203] offset:1536
    s_mov_b64 exec, -1
    s_waitcnt lgkmcnt(0)
    s_barrier
    ds_read2st64_b32 v[192:193], v239 offset0:6 offset1:6
    v_xor_b32 v10, 64, v239
    ds_read2st64_b32 v[196:197], v10 offset0:6 offset1:6
    v_xor_b32 v10, 128, v239
    ds_read2st64_b32 v[144:145], v10 offset0:6 offset1:6
    v_xor_b32 v10, 192, v239
    ds_read2st64_b32 v[148:149], v10 offset0:6 offset1:6
    s_waitcnt lgkmcnt(3)
    v_mfma_f32_32x32x16_bf16 v[80:95], v[192:195], v[232:235], v[80:95]
    s_waitcnt lgkmcnt(2)
    v_mfma_f32_32x32x16_bf16 v[96:111], v[196:199], v[232:235], v[96:111]
    s_waitcnt lgkmcnt(1)
    v_mfma_f32_32x32x16_bf16 v[112:127], v[144:147], v[232:235], v[112:127]
    s_waitcnt lgkmcnt(0)
    v_mfma_f32_32x32x16_bf16 v[128:143], v[148:151], v[232:235], v[128:143]
    s_xor_b32 s79, s68, 0
    s_lshl_b32 s79, s79, 10
    s_add_u32 s79, s79, s7
    s_nop 2
    v_pk_mul_f32 v[80:81], v[80:81], v[88:89]
    v_pk_mul_f32 v[82:83], v[82:83], v[90:91]
    v_pk_mul_f32 v[84:85], v[84:85], v[92:93]
    v_pk_mul_f32 v[86:87], v[86:87], v[94:95]
    v_cvt_pk_bf16_f32 v88, v80, v81
    v_cvt_pk_bf16_f32 v89, v82, v83
    v_cvt_pk_bf16_f32 v90, v84, v85
    v_cvt_pk_bf16_f32 v91, v86, v87
    buffer_store_dwordx4 v[88:91], v1, s[48:51], s79 offen  sc1
    s_xor_b32 s79, s68, 1
    s_lshl_b32 s79, s79, 10
    s_add_u32 s79, s79, s7
    v_pk_mul_f32 v[96:97], v[96:97], v[104:105]
    v_pk_mul_f32 v[98:99], v[98:99], v[106:107]
    v_pk_mul_f32 v[100:101], v[100:101], v[108:109]
    v_pk_mul_f32 v[102:103], v[102:103], v[110:111]
    v_cvt_pk_bf16_f32 v104, v96, v97
    v_cvt_pk_bf16_f32 v105, v98, v99
    v_cvt_pk_bf16_f32 v106, v100, v101
    v_cvt_pk_bf16_f32 v107, v102, v103
    buffer_store_dwordx4 v[104:107], v1, s[48:51], s79 offen  sc1
    s_xor_b32 s79, s68, 2
    s_lshl_b32 s79, s79, 10
    s_add_u32 s79, s79, s7
    v_pk_mul_f32 v[112:113], v[112:113], v[120:121]
    v_pk_mul_f32 v[114:115], v[114:115], v[122:123]
    v_pk_mul_f32 v[116:117], v[116:117], v[124:125]
    v_pk_mul_f32 v[118:119], v[118:119], v[126:127]
    v_cvt_pk_bf16_f32 v120, v112, v113
    v_cvt_pk_bf16_f32 v121, v114, v115
    v_cvt_pk_bf16_f32 v122, v116, v117
    v_cvt_pk_bf16_f32 v123, v118, v119
    buffer_store_dwordx4 v[120:123], v1, s[48:51], s79 offen  sc1
    s_xor_b32 s79, s68, 3
    s_lshl_b32 s79, s79, 10
    s_add_u32 s79, s79, s7
    v_pk_mul_f32 v[128:129], v[128:129], v[136:137]
    v_pk_mul_f32 v[130:131], v[130:131], v[138:139]
    v_pk_mul_f32 v[132:133], v[132:133], v[140:141]
    v_pk_mul_f32 v[134:135], v[134:135], v[142:143]
    v_cvt_pk_bf16_f32 v136, v128, v129
    v_cvt_pk_bf16_f32 v137, v130, v131
    v_cvt_pk_bf16_f32 v138, v132, v133
    v_cvt_pk_bf16_f32 v139, v134, v135
    buffer_store_dwordx4 v[136:139], v1, s[48:51], s79 offen  sc1
    s_waitcnt vmcnt(22)
    v_mfma_f32_32x32x16_bf16 a[96:111], a[128:131], a[0:3], 0
    s_add_u32 s85, s10, 24576
    buffer_load_dwordx4 a[48:51], v1, s[48:51], s85 offen sc1
    v_mfma_f32_32x32x16_bf16 a[112:127], a[132:135], a[0:3], 0
    s_waitcnt vmcnt(21)
    v_mfma_f32_32x32x16_bf16 a[64:79], a[128:131], a[4:7], 0
    s_add_u32 s85, s11, 24576
    buffer_load_dwordx4 a[52:55], v1, s[48:51], s85 offen sc1
    v_mfma_f32_32x32x16_bf16 a[80:95], a[132:135], a[4:7], 0
    s_waitcnt vmcnt(20)
    v_mfma_f32_32x32x16_bf16 a[96:111], a[136:139], a[8:11], a[96:111]
    s_add_u32 s85, s10, 28672
    buffer_load_dwordx4 a[56:59], v1, s[48:51], s85 offen sc1
    v_mfma_f32_32x32x16_bf16 a[112:127], a[140:143], a[8:11], a[112:127]
    s_waitcnt vmcnt(20)
    v_mfma_f32_32x32x16_bf16 a[64:79], a[136:139], a[12:15], a[64:79]
    s_add_u32 s85, s11, 28672
    buffer_load_dwordx4 a[60:63], v1, s[48:51], s85 offen sc1
    v_mfma_f32_32x32x16_bf16 a[80:95], a[140:143], a[12:15], a[80:95]
    s_waitcnt vmcnt(19)
    v_mfma_f32_32x32x16_bf16 a[96:111], a[144:147], a[16:19], a[96:111]
    s_add_u32 s85, s10, 32768
    buffer_load_dwordx4 a[0:3], v1, s[48:51], s85 offen sc1
    v_mfma_f32_32x32x16_bf16 a[112:127], a[148:151], a[16:19], a[112:127]
    s_waitcnt vmcnt(18)
    v_mfma_f32_32x32x16_bf16 a[64:79], a[144:147], a[20:23], a[64:79]
    s_add_u32 s85, s11, 32768
    buffer_load_dwordx4 a[4:7], v1, s[48:51], s85 offen sc1
    v_mfma_f32_32x32x16_bf16 a[80:95], a[148:151], a[20:23], a[80:95]
    s_waitcnt vmcnt(6)
    v_mfma_f32_32x32x16_bf16 a[96:111], a[152:155], a[24:27], a[96:111]
    v_mov_b32 v12, 2
    s_mov_b64 exec, 1
    buffer_store_dword v12, v11, s[52:55], s74 offen offset:512
    buffer_store_dword v12, v11, s[56:59], s74 offen offset:512 sc1
    s_mov_b64 exec, -1
    v_mfma_f32_32x32x16_bf16 a[112:127], a[156:159], a[24:27], a[112:127]
    s_add_u32 s85, s10, 36864
    buffer_load_dwordx4 a[8:11], v1, s[48:51], s85 offen sc1
    ds_read_b64_tr_b16 v[250:251], v208 offset:41984
    ds_read_b64_tr_b16 v[254:255], v209 offset:41984
    v_mfma_f32_32x32x16_bf16 a[64:79], a[152:155], a[28:31], a[64:79]
    s_add_u32 s85, s11, 36864
    buffer_load_dwordx4 a[12:15], v1, s[48:51], s85 offen sc1
    v_mfma_f32_32x32x16_bf16 a[80:95], a[156:159], a[28:31], a[80:95]
    s_add_u32 m0, s3, 19456
    s_add_u32 s0, s101, 1253376
    buffer_load_dwordx4 v210, s[40:43], s0 offen lds
    v_mfma_f32_32x32x16_bf16 a[96:111], a[160:163], a[32:35], a[96:111]
    s_add_u32 s85, s10, 40960
    buffer_load_dwordx4 a[16:19], v1, s[48:51], s85 offen sc1
    s_waitcnt lgkmcnt(0)
    v_mfma_f32_32x32x16_bf16 a[112:127], a[164:167], a[32:35], a[112:127]
    s_add_u32 m0, s3, 40960
    s_add_u32 s0, s101, 1376256
    buffer_load_dwordx4 v210, s[40:43], s0 offen lds
    v_mfma_f32_32x32x16_bf16 a[64:79], a[160:163], a[36:39], a[64:79]
    s_add_u32 s85, s11, 40960
    buffer_load_dwordx4 a[20:23], v1, s[48:51], s85 offen sc1
    v_mfma_f32_32x32x16_bf16 a[80:95], a[164:167], a[36:39], a[80:95]
    s_add_u32 m0, s3, 41984
    s_add_u32 s0, s101, 1384448
    buffer_load_dwordx4 v210, s[40:43], s0 offen lds
    ds_read_b64_tr_b16 v[16:17], v208 offset:2048
    v_mfma_f32_32x32x16_bf16 a[96:111], a[168:171], a[40:43], a[96:111]
    s_add_u32 s85, s10, 45056
    buffer_load_dwordx4 a[24:27], v1, s[48:51], s85 offen sc1
    ds_read_b64_tr_b16 v[20:21], v209 offset:2048
    ds_read_b64_tr_b16 v[18:19], v208 offset:3072
    ds_read_b64_tr_b16 v[22:23], v209 offset:3072
    v_mfma_f32_32x32x16_bf16 a[112:127], a[172:175], a[40:43], a[112:127]
    v_mfma_f32_32x32x16_bf16 a[64:79], a[168:171], a[44:47], a[64:79]
    s_add_u32 s85, s11, 45056
    buffer_load_dwordx4 a[28:31], v1, s[48:51], s85 offen sc1
    v_mfma_f32_32x32x16_bf16 a[80:95], a[172:175], a[44:47], a[80:95]
    s_waitcnt lgkmcnt(0)
    s_add_u32 m0, s3, 2048
    s_add_u32 s0, s101, 1507328
    buffer_load_dwordx4 v210, s[40:43], s0 offen lds
    s_waitcnt vmcnt(17)
    v_mfma_f32_32x32x16_bf16 a[96:111], a[176:179], a[48:51], a[96:111]
    s_add_u32 s85, s10, 49152
    buffer_load_dwordx4 a[32:35], v1, s[48:51], s85 offen sc1
    ds_read_b64_tr_b16 v[24:25], v208 offset:49152
    ds_read_b64_tr_b16 v[28:29], v209 offset:49152
    ds_read_b64_tr_b16 v[26:27], v208 offset:50176
    v_mfma_f32_32x32x16_bf16 a[112:127], a[180:183], a[48:51], a[112:127]
    ds_read_b64_tr_b16 v[30:31], v209 offset:50176
    s_add_u32 m0, s3, 3072
    s_add_u32 s0, s101, 1515520
    buffer_load_dwordx4 v210, s[40:43], s0 offen lds
    s_waitcnt vmcnt(18)
    v_mfma_f32_32x32x16_bf16 a[64:79], a[176:179], a[52:55], a[64:79]
    s_add_u32 s85, s11, 49152
    buffer_load_dwordx4 a[36:39], v1, s[48:51], s85 offen sc1
    ds_read_b64_tr_b16 v[32:33], v208 offset:57344
    ds_read_b64_tr_b16 v[36:37], v209 offset:57344
    ds_read_b64_tr_b16 v[34:35], v208 offset:58368
    v_mfma_f32_32x32x16_bf16 a[80:95], a[180:183], a[52:55], a[80:95]
    ds_read_b64_tr_b16 v[38:39], v209 offset:58368
    ds_read_b64_tr_b16 v[40:41], v208 offset:32768
    ds_read_b64_tr_b16 v[44:45], v209 offset:32768
    s_waitcnt vmcnt(18)
    v_mfma_f32_32x32x16_bf16 a[96:111], a[184:187], a[56:59], a[96:111]
    s_add_u32 s85, s10, 53248
    buffer_load_dwordx4 a[40:43], v1, s[48:51], s85 offen sc1
    ds_read_b64_tr_b16 v[42:43], v208 offset:33792
    ds_read_b64_tr_b16 v[46:47], v209 offset:33792
    v_mfma_f32_32x32x16_bf16 a[112:127], a[188:191], a[56:59], a[112:127]
    s_and_b32 s76, s70, 8
    s_lshl_b32 s76, s76, 5
    s_lshl_b32 s77, s12, 7
    s_add_u32 s76, s76, s77
    v_and_b32 v10, 31, v0
    v_lshl_add_u32 v10, v10, 2, s76
    s_waitcnt vmcnt(18)
    v_mfma_f32_32x32x16_bf16 a[64:79], a[184:187], a[60:63], a[64:79]
    s_add_u32 s85, s11, 53248
    buffer_load_dwordx4 a[44:47], v1, s[48:51], s85 offen sc1
    s_waitcnt lgkmcnt(4)
    ds_read_b32 v120, v10 offset:0
    s_xor_b32 s76, s68, 0
    s_lshl_b32 s76, s76, 12
    v_mfma_f32_32x32x16_bf16 a[80:95], a[188:191], a[60:63], a[80:95]
    s_add_u32 m0, s3, 57344
    s_add_u32 s0, s101, 1638400
    buffer_load_dwordx4 v210, s[40:43], s0 offen lds
    ds_read_b64_tr_b16 v[48:49], v208 offset:10240
    s_waitcnt vmcnt(19)
    v_mfma_f32_32x32x16_bf16 a[96:111], a[192:195], a[0:3], a[96:111]
    buffer_load_dword v12, v223, s[48:51], s74 offen offset:512 sc1
    ds_read_b64_tr_b16 v[52:53], v209 offset:10240
    ds_read_b64_tr_b16 v[50:51], v208 offset:11264
    ds_read_b64_tr_b16 v[54:55], v209 offset:11264
    v_add_u32 v144, s76, v1
    s_xor_b32 s76, s68, 1
    v_mfma_f32_32x32x16_bf16 a[112:127], a[196:199], a[0:3], a[112:127]
    s_add_u32 m0, s3, 58368
    s_add_u32 s0, s101, 1646592
    buffer_load_dwordx4 v210, s[40:43], s0 offen lds
    s_waitcnt lgkmcnt(5)
    s_lshl_b32 s76, s76, 12
    s_waitcnt vmcnt(20)
    v_mfma_f32_32x32x16_bf16 a[64:79], a[192:195], a[4:7], a[64:79]
    s_add_u32 m0, s3, 32768
    s_add_u32 s0, s101, 1769472
    buffer_load_dwordx4 v210, s[40:43], s0 offen lds
    s_waitcnt vmcnt(16)
    ds_read_b64_tr_b16 v[56:57], v208 offset:18432
    ds_read_b64_tr_b16 v[60:61], v209 offset:18432
    v_mfma_f32_32x32x16_bf16 a[80:95], a[196:199], a[4:7], a[80:95]
    ds_read_b64_tr_b16 v[58:59], v208 offset:19456
    ds_read_b64_tr_b16 v[62:63], v209 offset:19456
    s_add_u32 m0, s3, 33792
    s_add_u32 s0, s101, 1777664
    buffer_load_dwordx4 v210, s[40:43], s0 offen lds
    v_mfma_f32_32x32x16_bf16 a[96:111], a[200:203], a[8:11], a[96:111]
    s_waitcnt vmcnt(13)
    ds_read_b64_tr_b16 v[64:65], v208 offset:40960
    ds_read_b64_tr_b16 v[68:69], v209 offset:40960
    ds_read_b64_tr_b16 v[66:67], v208 offset:41984
    v_add_u32 v145, s76, v1
    s_xor_b32 s76, s68, 2
    s_lshl_b32 s76, s76, 12
    v_mfma_f32_32x32x16_bf16 a[112:127], a[204:207], a[8:11], a[112:127]
    ds_read_b64_tr_b16 v[70:71], v209 offset:41984
    v_add_u32 v146, s76, v1
    s_xor_b32 s76, s68, 3
    s_lshl_b32 s76, s76, 12
    v_add_u32 v147, s76, v1
    v_and_b32 v10, 31, v0
    v_mfma_f32_32x32x16_bf16 a[64:79], a[200:203], a[12:15], a[64:79]
    v_lshl_add_u32 v10, v10, 10, v220
    s_lshl_b32 s77, s71, 1
    s_add_u32 s77, s77, s12
    s_lshl_b32 s77, s77, 15
    s_lshl_b32 s76, s72, 7
    s_add_u32 s77, s77, s76
    s_and_b32 s76, s68, 1
    v_mfma_f32_32x32x16_bf16 a[80:95], a[204:207], a[12:15], a[80:95]
    s_waitcnt vmcnt(8)
    ds_read_b64_tr_b16 v[72:73], v208 offset:2048
    ds_read_b64_tr_b16 v[76:77], v209 offset:2048
    ds_read_b64_tr_b16 v[74:75], v208 offset:3072
    s_lshl_b32 s76, s76, 6
    s_add_u32 s77, s77, s76
    v_mfma_f32_32x32x16_bf16 a[96:111], a[208:211], a[16:19], a[96:111]
    s_waitcnt vmcnt(3)
    s_mov_b32 s84, 0
L_spinl_87:
    v_cmp_gt_u32 vcc, 2, v12
    s_add_u32 s84, s84, 1
    s_cbranch_vccz L_donel_88
    buffer_load_dword v12, v223, s[48:51], s74 offen offset:512 sc1
    s_cmp_ge_u32 s84, 400000
    s_waitcnt vmcnt(0)
    s_cbranch_scc0 L_spinl_87
L_donel_88:
    s_add_u32 s85, s10, 57344
    ds_read_b64_tr_b16 v[78:79], v209 offset:3072
    v_mfma_f32_32x32x16_bf16 a[112:127], a[212:215], a[16:19], a[112:127]
    buffer_load_dwordx4 a[48:51], v1, s[48:51], s85 offen sc1
    s_add_u32 s85, s11, 57344
    v_lshlrev_b32 v96, 16, v2
    v_and_b32 v97, 0xffff0000, v2
    v_lshlrev_b32 v98, 16, v3
    v_mfma_f32_32x32x16_bf16 a[64:79], a[208:211], a[20:23], a[64:79]
    buffer_load_dwordx4 a[52:55], v1, s[48:51], s85 offen sc1
    s_add_u32 s85, s10, 61440
    v_and_b32 v99, 0xffff0000, v3
    v_lshlrev_b32 v100, 16, v4
    v_and_b32 v101, 0xffff0000, v4
    v_lshlrev_b32 v102, 16, v5
    v_mfma_f32_32x32x16_bf16 a[80:95], a[212:215], a[20:23], a[80:95]
    buffer_load_dwordx4 a[56:59], v1, s[48:51], s85 offen sc1
    s_add_u32 s85, s11, 61440
    v_and_b32 v103, 0xffff0000, v5
    v_lshlrev_b32 v104, 16, v6
    v_and_b32 v105, 0xffff0000, v6
    v_mfma_f32_32x32x16_bf16 a[96:111], a[216:219], a[24:27], a[96:111]
    buffer_load_dwordx4 a[60:63], v1, s[48:51], s85 offen sc1
    s_add_u32 s85, s10, 65536
    v_lshlrev_b32 v106, 16, v7
    v_and_b32 v107, 0xffff0000, v7
    v_lshlrev_b32 v108, 16, v8
    v_and_b32 v109, 0xffff0000, v8
    v_mfma_f32_32x32x16_bf16 a[112:127], a[220:223], a[24:27], a[112:127]
    buffer_load_dwordx4 a[0:3], v1, s[48:51], s85 offen sc1
    s_add_u32 s85, s11, 65536
    v_lshlrev_b32 v110, 16, v9
    v_and_b32 v111, 0xffff0000, v9
    v_mfma_f32_32x32x16_bf16 a[64:79], a[216:219], a[28:31], a[64:79]
    buffer_load_dwordx4 a[4:7], v1, s[48:51], s85 offen sc1
    s_add_u32 s85, s10, 69632
    v_mfma_f32_32x32x16_bf16 a[80:95], a[220:223], a[28:31], a[80:95]
    buffer_load_dwordx4 a[8:11], v1, s[48:51], s85 offen sc1
    s_add_u32 s85, s11, 69632
    s_waitcnt vmcnt(9)
    ds_read_b64_tr_b16 v[224:225], v208 offset:57344
    ds_read_b64_tr_b16 v[228:229], v209 offset:57344
    v_mfma_f32_32x32x16_bf16 a[96:111], a[224:227], a[32:35], a[96:111]
    buffer_load_dwordx4 a[12:15], v1, s[48:51], s85 offen sc1
    s_add_u32 s85, s10, 73728
    ds_read_b64_tr_b16 v[226:227], v208 offset:58368
    ds_read_b64_tr_b16 v[230:231], v209 offset:58368
    v_mfma_f32_32x32x16_bf16 a[112:127], a[228:231], a[32:35], a[112:127]
    buffer_load_dwordx4 a[16:19], v1, s[48:51], s85 offen sc1
    s_waitcnt vmcnt(9)
    ds_read_b64_tr_b16 v[232:233], v208 offset:32768
    ds_read_b64_tr_b16 v[236:237], v209 offset:32768
    ds_read_b64_tr_b16 v[234:235], v208 offset:33792
    v_mfma_f32_32x32x16_bf16 a[64:79], a[224:227], a[36:39], a[64:79]
    s_add_u32 s85, s11, 73728
    buffer_load_dwordx4 a[20:23], v1, s[48:51], s85 offen sc1
    ds_read_b64_tr_b16 v[238:239], v209 offset:33792
    v_mfma_f32_32x32x16_bf16 a[80:95], a[228:231], a[36:39], a[80:95]
    v_mfma_f32_32x32x16_bf16 a[96:111], a[232:235], a[40:43], a[96:111]
    s_add_u32 s85, s10, 77824
    buffer_load_dwordx4 a[24:27], v1, s[48:51], s85 offen sc1
    v_mfma_f32_32x32x16_bf16 a[112:127], a[236:239], a[40:43], a[112:127]
    v_mfma_f32_32x32x16_bf16 a[64:79], a[232:235], a[44:47], a[64:79]
    s_add_u32 s85, s11, 77824
    buffer_load_dwordx4 a[28:31], v1, s[48:51], s85 offen sc1
    v_mfma_f32_32x32x16_bf16 a[80:95], a[236:239], a[44:47], a[80:95]
    s_waitcnt vmcnt(11)
    v_mfma_f32_32x32x16_bf16 a[96:111], a[240:243], a[48:51], a[96:111]
    s_add_u32 s85, s10, 81920
    buffer_load_dwordx4 a[32:35], v1, s[48:51], s85 offen sc1
    v_mfma_f32_32x32x16_bf16 a[112:127], a[244:247], a[48:51], a[112:127]
    s_waitcnt vmcnt(11)
    v_mfma_f32_32x32x16_bf16 a[64:79], a[240:243], a[52:55], a[64:79]
    s_add_u32 s85, s10, 86016
    buffer_load_dwordx4 a[36:39], v1, s[48:51], s85 offen sc1
    v_mfma_f32_32x32x16_bf16 a[80:95], a[244:247], a[52:55], a[80:95]
    s_waitcnt vmcnt(11)
    v_mfma_f32_32x32x16_bf16 a[96:111], a[248:251], a[56:59], a[96:111]
    s_add_u32 s85, s10, 90112
    buffer_load_dwordx4 a[40:43], v1, s[48:51], s85 offen sc1
    v_mfma_f32_32x32x16_bf16 a[112:127], a[252:255], a[56:59], a[112:127]
    s_waitcnt vmcnt(11)
    v_mfma_f32_32x32x16_bf16 a[64:79], a[248:251], a[60:63], a[64:79]
    s_add_u32 s85, s10, 94208
    buffer_load_dwordx4 a[44:47], v1, s[48:51], s85 offen sc1
    v_mfma_f32_32x32x16_bf16 a[80:95], a[252:255], a[60:63], a[80:95]
    s_waitcnt vmcnt(11)
    v_mfma_f32_32x32x16_bf16 a[96:111], v[240:243], a[0:3], a[96:111]
    s_add_u32 s85, s10, 98304
    buffer_load_dwordx4 a[48:51], v1, s[48:51], s85 offen sc1
    v_mfma_f32_32x32x16_bf16 a[112:127], v[244:247], a[0:3], a[112:127]
    s_waitcnt vmcnt(11)
    v_mfma_f32_32x32x16_bf16 a[64:79], v[240:243], a[4:7], a[64:79]
    s_add_u32 s85, s10, 102400
    buffer_load_dwordx4 a[52:55], v1, s[48:51], s85 offen sc1
    v_mfma_f32_32x32x16_bf16 a[80:95], v[244:247], a[4:7], a[80:95]
    s_waitcnt vmcnt(11)
    v_mfma_f32_32x32x16_bf16 a[96:111], v[248:251], a[8:11], a[96:111]
    s_add_u32 s85, s10, 106496
    buffer_load_dwordx4 a[56:59], v1, s[48:51], s85 offen sc1
    v_mfma_f32_32x32x16_bf16 a[112:127], v[252:255], a[8:11], a[112:127]
    s_waitcnt vmcnt(11)
    v_mfma_f32_32x32x16_bf16 a[64:79], v[248:251], a[12:15], a[64:79]
    s_add_u32 s85, s10, 110592
    buffer_load_dwordx4 a[60:63], v1, s[48:51], s85 offen sc1
    v_mfma_f32_32x32x16_bf16 a[80:95], v[252:255], a[12:15], a[80:95]
    s_waitcnt vmcnt(11)
    v_mfma_f32_32x32x16_bf16 a[96:111], v[16:19], a[16:19], a[96:111]
    s_add_u32 s85, s11, 81920
    buffer_load_dwordx4 a[0:3], v1, s[48:51], s85 offen sc1
    v_mfma_f32_32x32x16_bf16 a[112:127], v[20:23], a[16:19], a[112:127]
    s_waitcnt vmcnt(11)
    v_mfma_f32_32x32x16_bf16 a[64:79], v[16:19], a[20:23], a[64:79]
    s_add_u32 s85, s11, 86016
    buffer_load_dwordx4 a[4:7], v1, s[48:51], s85 offen sc1
    v_mfma_f32_32x32x16_bf16 a[80:95], v[20:23], a[20:23], a[80:95]
    s_waitcnt vmcnt(11)
    v_mfma_f32_32x32x16_bf16 a[96:111], v[24:27], a[24:27], a[96:111]
    s_add_u32 s85, s11, 90112
    buffer_load_dwordx4 a[8:11], v1, s[48:51], s85 offen sc1
    v_mfma_f32_32x32x16_bf16 a[112:127], v[28:31], a[24:27], a[112:127]
    s_waitcnt vmcnt(11)
    v_mfma_f32_32x32x16_bf16 a[64:79], v[24:27], a[28:31], a[64:79]
    s_add_u32 s85, s11, 94208
    buffer_load_dwordx4 a[12:15], v1, s[48:51], s85 offen sc1
    v_mfma_f32_32x32x16_bf16 a[80:95], v[28:31], a[28:31], a[80:95]
    s_waitcnt vmcnt(11)
    v_mfma_f32_32x32x16_bf16 a[96:111], v[32:35], a[32:35], a[96:111]
    s_add_u32 s85, s11, 98304
    buffer_load_dwordx4 a[16:19], v1, s[48:51], s85 offen sc1
    v_mfma_f32_32x32x16_bf16 a[112:127], v[36:39], a[32:35], a[112:127]
    s_waitcnt vmcnt(11)
    v_mfma_f32_32x32x16_bf16 a[96:111], v[40:43], a[36:39], a[96:111]
    s_add_u32 s85, s11, 102400
    buffer_load_dwordx4 a[20:23], v1, s[48:51], s85 offen sc1
    v_mfma_f32_32x32x16_bf16 a[112:127], v[44:47], a[36:39], a[112:127]
    s_waitcnt vmcnt(11) lgkmcnt(15)
    v_mfma_f32_32x32x16_bf16 a[96:111], v[48:51], a[40:43], a[96:111]
    s_add_u32 s85, s11, 106496
    buffer_load_dwordx4 a[24:27], v1, s[48:51], s85 offen sc1
    v_mfma_f32_32x32x16_bf16 a[112:127], v[52:55], a[40:43], a[112:127]
    s_waitcnt vmcnt(11)
    v_mfma_f32_32x32x16_bf16 a[96:111], v[56:59], a[44:47], a[96:111]
    s_add_u32 s85, s11, 110592
    buffer_load_dwordx4 a[28:31], v1, s[48:51], s85 offen sc1
    v_mfma_f32_32x32x16_bf16 a[112:127], v[60:63], a[44:47], a[112:127]
    s_waitcnt vmcnt(11) lgkmcnt(12)
    v_mfma_f32_32x32x16_bf16 a[96:111], v[64:67], a[48:51], a[96:111]
    v_mfma_f32_32x32x16_bf16 a[112:127], v[68:71], a[48:51], a[112:127]
    s_waitcnt vmcnt(10) lgkmcnt(8)
    v_mfma_f32_32x32x16_bf16 a[96:111], v[72:75], a[52:55], a[96:111]
    v_mfma_f32_32x32x16_bf16 a[112:127], v[76:79], a[52:55], a[112:127]
    s_waitcnt vmcnt(9) lgkmcnt(4)
    v_mfma_f32_32x32x16_bf16 a[96:111], v[224:227], a[56:59], a[96:111]
    v_mfma_f32_32x32x16_bf16 a[112:127], v[228:231], a[56:59], a[112:127]
    s_waitcnt vmcnt(8) lgkmcnt(0)
    v_mfma_f32_32x32x16_bf16 a[96:111], v[232:235], a[60:63], a[96:111]
    s_barrier
    v_mfma_f32_32x32x16_bf16 a[112:127], v[236:239], a[60:63], a[112:127]
    s_waitcnt vmcnt(7)
    v_mfma_f32_32x32x16_bf16 a[80:95], v[36:39], a[0:3], a[80:95]
    s_waitcnt vmcnt(6)
    v_mfma_f32_32x32x16_bf16 a[80:95], v[44:47], a[4:7], a[80:95]
    s_nop 5
    ds_write_b128 v146, a[96:99] offset:18432
    ds_write_b128 v146, a[100:103] offset:19456
    s_waitcnt vmcnt(5)
    v_mfma_f32_32x32x16_bf16 a[80:95], v[52:55], a[8:11], a[80:95]
    ds_write_b128 v146, a[104:107] offset:20480
    s_waitcnt vmcnt(4)
    v_mfma_f32_32x32x16_bf16 a[80:95], v[60:63], a[12:15], a[80:95]
    ds_write_b128 v146, a[108:111] offset:21504
    s_waitcnt vmcnt(3)
    v_mfma_f32_32x32x16_bf16 a[80:95], v[68:71], a[16:19], a[80:95]
    ds_write_b128 v147, a[112:115] offset:34816
    s_waitcnt vmcnt(2)
    v_mfma_f32_32x32x16_bf16 a[80:95], v[76:79], a[20:23], a[80:95]
    ds_write_b128 v147, a[116:119] offset:35840
    s_waitcnt vmcnt(1)
    v_mfma_f32_32x32x16_bf16 a[80:95], v[228:231], a[24:27], a[80:95]
    ds_write_b128 v147, a[120:123] offset:36864
    s_waitcnt vmcnt(0)
    v_mfma_f32_32x32x16_bf16 a[80:95], v[236:239], a[28:31], a[80:95]
    ds_write_b128 v147, a[124:127] offset:37888
    v_mfma_f32_32x32x16_bf16 a[64:79], v[32:35], a[0:3], a[64:79]
    v_mfma_f32_32x32x16_bf16 a[64:79], v[40:43], a[4:7], a[64:79]
    s_waitcnt lgkmcnt(0)
    s_barrier
    ds_read_b128 v[164:167], v144 offset:18432
    ds_read_b128 v[168:171], v144 offset:19456
    ds_read_b128 v[172:175], v144 offset:20480
    ds_read_b128 v[176:179], v144 offset:21504
    v_mfma_f32_32x32x16_bf16 a[64:79], v[48:51], a[8:11], a[64:79]
    ds_read_b128 v[180:183], v144 offset:34816
    ds_read_b128 v[184:187], v144 offset:35840
    ds_read_b128 v[188:191], v144 offset:36864
    ds_read_b128 v[192:195], v144 offset:37888
    v_mfma_f32_32x32x16_bf16 a[64:79], v[56:59], a[12:15], a[64:79]
    ds_write_b128 v145, a[80:83] offset:2048
    v_mfma_f32_32x32x16_bf16 a[64:79], v[64:67], a[16:19], a[64:79]
    ds_write_b128 v145, a[84:87] offset:3072
    v_mfma_f32_32x32x16_bf16 a[64:79], v[72:75], a[20:23], a[64:79]
    ds_write_b128 v145, a[88:91] offset:4096
    v_mfma_f32_32x32x16_bf16 a[64:79], v[224:227], a[24:27], a[64:79]
    ds_write_b128 v145, a[92:95] offset:5120
    v_mfma_f32_32x32x16_bf16 a[64:79], v[232:235], a[28:31], a[64:79]
    s_waitcnt lgkmcnt(0)
    s_barrier
    ds_read_b128 v[148:151], v144 offset:2048
    ds_read_b128 v[152:155], v144 offset:3072
    ds_read_b128 v[156:159], v144 offset:4096
    ds_read_b128 v[160:163], v144 offset:5120
    v_pk_add_f32 v[164:165], v[164:165], v[180:181]
    v_pk_add_f32 v[166:167], v[166:167], v[182:183]
    v_pk_add_f32 v[168:169], v[168:169], v[184:185]
    v_pk_add_f32 v[170:171], v[170:171], v[186:187]
    v_pk_add_f32 v[172:173], v[172:173], v[188:189]
    v_pk_add_f32 v[174:175], v[174:175], v[190:191]
    v_pk_add_f32 v[176:177], v[176:177], v[192:193]
    v_pk_add_f32 v[178:179], v[178:179], v[194:195]
    v_accvgpr_read_b32 v80, a64
    v_accvgpr_read_b32 v81, a65
    v_accvgpr_read_b32 v82, a66
    v_accvgpr_read_b32 v83, a67
    v_accvgpr_read_b32 v84, a68
    v_accvgpr_read_b32 v85, a69
    v_accvgpr_read_b32 v86, a70
    v_accvgpr_read_b32 v87, a71
    v_accvgpr_read_b32 v88, a72
    v_accvgpr_read_b32 v89, a73
    v_accvgpr_read_b32 v90, a74
    v_accvgpr_read_b32 v91, a75
    v_accvgpr_read_b32 v92, a76
    v_accvgpr_read_b32 v93, a77
    v_accvgpr_read_b32 v94, a78
    v_accvgpr_read_b32 v95, a79
L_pad_4:
    s_cbranch_execz L_walk_2
    v_pk_add_f32 v[80:81], v[80:81], v[164:165]
    v_pk_add_f32 v[82:83], v[82:83], v[166:167]
    v_pk_add_f32 v[84:85], v[84:85], v[168:169]
    v_pk_add_f32 v[86:87], v[86:87], v[170:171]
    v_pk_add_f32 v[88:89], v[88:89], v[172:173]
    v_pk_add_f32 v[90:91], v[90:91], v[174:175]
    v_pk_add_f32 v[92:93], v[92:93], v[176:177]
    v_pk_add_f32 v[94:95], v[94:95], v[178:179]
    s_waitcnt lgkmcnt(0)
    v_pk_add_f32 v[80:81], v[80:81], v[148:149]
    v_pk_add_f32 v[82:83], v[82:83], v[150:151]
    v_pk_add_f32 v[84:85], v[84:85], v[152:153]
    v_pk_add_f32 v[86:87], v[86:87], v[154:155]
    v_pk_fma_f32 v[80:81], v[80:81], v[120:121], v[96:97] op_sel_hi:[1,0,1]
    v_pk_fma_f32 v[82:83], v[82:83], v[120:121], v[98:99] op_sel_hi:[1,0,1]
    v_pk_fma_f32 v[84:85], v[84:85], v[120:121], v[100:101] op_sel_hi:[1,0,1]
    v_pk_fma_f32 v[86:87], v[86:87], v[120:121], v[102:103] op_sel_hi:[1,0,1]
    v_cvt_pk_bf16_f32 v112, v80, v81
    v_cvt_pk_bf16_f32 v113, v82, v83
    v_cvt_pk_bf16_f32 v114, v84, v85
    v_cvt_pk_bf16_f32 v115, v86, v87
    s_nop 0
    v_permlane32_swap_b32 v112, v114
    v_permlane32_swap_b32 v113, v115
    buffer_store_dwordx4 v[112:115], v10, s[44:47], s77 offen offset:0
    v_pk_add_f32 v[88:89], v[88:89], v[156:157]
    v_pk_add_f32 v[90:91], v[90:91], v[158:159]
    v_pk_add_f32 v[92:93], v[92:93], v[160:161]
    v_pk_add_f32 v[94:95], v[94:95], v[162:163]
    v_pk_fma_f32 v[88:89], v[88:89], v[120:121], v[104:105] op_sel_hi:[1,0,1]
    v_pk_fma_f32 v[90:91], v[90:91], v[120:121], v[106:107] op_sel_hi:[1,0,1]
    v_pk_fma_f32 v[92:93], v[92:93], v[120:121], v[108:109] op_sel_hi:[1,0,1]
    v_pk_fma_f32 v[94:95], v[94:95], v[120:121], v[110:111] op_sel_hi:[1,0,1]
    v_cvt_pk_bf16_f32 v116, v88, v89
    v_cvt_pk_bf16_f32 v117, v90, v91
    v_cvt_pk_bf16_f32 v118, v92, v93
    v_cvt_pk_bf16_f32 v119, v94, v95
    s_nop 0
    v_permlane32_swap_b32 v116, v118
    v_permlane32_swap_b32 v117, v119
    buffer_store_dwordx4 v[116:119], v10, s[44:47], s77 offen offset:32
    s_endpgm
L_idle_20:
    s_waitcnt vmcnt(6)
    ds_read_b64_tr_b16 a[128:129], v208 offset:18432
    ds_read_b64_tr_b16 a[132:133], v209 offset:18432
    ds_read_b64_tr_b16 a[130:131], v208 offset:19456
    ds_read_b64_tr_b16 a[134:135], v209 offset:19456
    s_waitcnt vmcnt(2)
    ds_read_b64_tr_b16 a[136:137], v208 offset:32768
    ds_read_b64_tr_b16 a[140:141], v209 offset:32768
    ds_read_b64_tr_b16 a[138:139], v208 offset:33792
    ds_read_b64_tr_b16 a[142:143], v209 offset:33792
    s_mov_b32 s100, 3584
    s_lshl_b32 s76, s69, 1
    s_add_u32 s76, s76, s75
    s_sub_u32 s76, s76, 14
    s_lshl_b32 s76, s76, 1
    s_and_b32 s77, s68, 1
    s_add_u32 s76, s76, s77
    s_mul_i32 s76, s76, 28672
    v_mul_u32_u24 v10, 4682, v0
    v_lshrrev_b32 v10, 16, v10
    v_mul_u32_u24 v144, 14, v10
    v_sub_u32 v144, v0, v144
    v_lshlrev_b32 v144, 8, v144
    v_mad_u32_u24 v144, v10, s100, v144
    buffer_load_dword v145, v144, s[36:39], s76 offen offset:128
    s_add_u32 s76, s76, 14336
    buffer_load_dword v145, v144, s[36:39], s76 offen offset:128
    s_add_u32 s76, s76, 14336
    s_and_b32 s76, s69, 1
    s_lshl_b32 s76, s76, 1
    s_add_u32 s76, s76, s75
    s_sub_u32 s76, s76, 14
    s_lshl_b32 s76, s76, 2
    s_add_u32 s76, s76, s68
    s_mul_i32 s76, s76, 56
    v_add_u32 v10, s76, v0
    v_lshrrev_b32 v144, 6, v10
    v_lshlrev_b32 v144, 17, v144
    v_and_b32 v10, 63, v10
    v_lshl_add_u32 v144, v10, 10, v144
    s_mov_b32 s76, 0
    buffer_load_dword v145, v144, s[40:43], s76 offen offset:384
    s_waitcnt vmcnt(0) lgkmcnt(0)
    s_barrier
    s_mov_b64 exec, 0
    s_branch L_pad_5
L_walk_3:
    s_mov_b64 exec, -1
    s_and_b32 s76, s69, 1
    s_lshl_b32 s76, s76, 1
    s_add_u32 s76, s76, s75
    s_sub_u32 s76, s76, 14
    s_lshl_b32 s76, s76, 1
    s_and_b32 s77, s68, 1
    s_add_u32 s76, s76, s77
    s_mul_i32 s76, s76, 229376
    v_lshrrev_b32 v10, 2, v0
    v_mul_u32_u24 v144, 3584, v10
    v_and_b32 v10, 1, v10
    v_lshl_add_u32 v144, v10, 9, v144
    v_and_b32 v10, 3, v0
    v_lshl_add_u32 v144, v10, 10, v144
    buffer_load_dword v145, v144, s[36:39], s76 offen offset:384
    s_add_u32 s76, s76, 57344
    buffer_load_dword v145, v144, s[36:39], s76 offen offset:384
    s_add_u32 s76, s76, 57344
    buffer_load_dword v145, v144, s[36:39], s76 offen offset:384
    s_add_u32 s76, s76, 57344
    buffer_load_dword v145, v144, s[36:39], s76 offen offset:384
    s_add_u32 s76, s76, 57344
    s_add_u32 m0, s3, 18432
    s_add_u32 s0, s101, 262144
    buffer_load_dwordx4 v210, s[40:43], s0 offen lds
    s_add_u32 m0, s3, 19456
    s_add_u32 s0, s101, 270336
    buffer_load_dwordx4 v210, s[40:43], s0 offen lds
    s_add_u32 m0, s3, 32768
    s_add_u32 s0, s101, 393216
    buffer_load_dwordx4 v210, s[40:43], s0 offen lds
    s_add_u32 m0, s3, 33792
    s_add_u32 s0, s101, 401408
    buffer_load_dwordx4 v210, s[40:43], s0 offen lds
    s_add_u32 m0, s3, 40960
    s_add_u32 s0, s101, 524288
    buffer_load_dwordx4 v210, s[40:43], s0 offen lds
    s_add_u32 m0, s3, 41984
    s_add_u32 s0, s101, 532480
    buffer_load_dwordx4 v210, s[40:43], s0 offen lds
    s_add_u32 m0, s3, 49152
    s_add_u32 s0, s101, 655360
    buffer_load_dwordx4 v210, s[40:43], s0 offen lds
    s_add_u32 m0, s3, 50176
    s_add_u32 s0, s101, 663552
    buffer_load_dwordx4 v210, s[40:43], s0 offen lds
    s_add_u32 m0, s3, 57344
    s_add_u32 s0, s101, 786432
    buffer_load_dwordx4 v210, s[40:43], s0 offen lds
    s_add_u32 m0, s3, 58368
    s_add_u32 s0, s101, 794624
    buffer_load_dwordx4 v210, s[40:43], s0 offen lds
    s_add_u32 m0, s3, 2048
    s_add_u32 s0, s101, 917504
    buffer_load_dwordx4 v210, s[40:43], s0 offen lds
    s_add_u32 m0, s3, 3072
    s_add_u32 s0, s101, 925696
    buffer_load_dwordx4 v210, s[40:43], s0 offen lds
    s_add_u32 m0, s3, 10240
    s_add_u32 s0, s101, 1048576
    buffer_load_dwordx4 v210, s[40:43], s0 offen lds
    s_add_u32 m0, s3, 11264
    s_add_u32 s0, s101, 1056768
    buffer_load_dwordx4 v210, s[40:43], s0 offen lds
    s_waitcnt vmcnt(12)
    ds_read_b64_tr_b16 a[144:145], v208 offset:18432
    ds_read_b64_tr_b16 a[148:149], v209 offset:18432
    ds_read_b64_tr_b16 a[146:147], v208 offset:19456
    ds_read_b64_tr_b16 a[150:151], v209 offset:19456
    s_waitcnt lgkmcnt(0)
    s_add_u32 m0, s3, 18432
    s_add_u32 s0, s101, 1179648
    buffer_load_dwordx4 v210, s[40:43], s0 offen lds
    s_add_u32 m0, s3, 19456
    s_add_u32 s0, s101, 1187840
    buffer_load_dwordx4 v210, s[40:43], s0 offen lds
    s_waitcnt vmcnt(12)
    ds_read_b64_tr_b16 a[152:153], v208 offset:32768
    ds_read_b64_tr_b16 a[156:157], v209 offset:32768
    ds_read_b64_tr_b16 a[154:155], v208 offset:33792
    ds_read_b64_tr_b16 a[158:159], v209 offset:33792
    s_waitcnt lgkmcnt(0)
    s_add_u32 m0, s3, 32768
    s_add_u32 s0, s101, 1310720
    buffer_load_dwordx4 v210, s[40:43], s0 offen lds
    s_add_u32 m0, s3, 33792
    s_add_u32 s0, s101, 1318912
    buffer_load_dwordx4 v210, s[40:43], s0 offen lds
    s_waitcnt vmcnt(12)
    ds_read_b64_tr_b16 a[160:161], v208 offset:40960
    ds_read_b64_tr_b16 a[164:165], v209 offset:40960
    ds_read_b64_tr_b16 a[162:163], v208 offset:41984
    ds_read_b64_tr_b16 a[166:167], v209 offset:41984
    s_waitcnt lgkmcnt(0)
    s_add_u32 m0, s3, 40960
    s_add_u32 s0, s101, 1441792
    buffer_load_dwordx4 v210, s[40:43], s0 offen lds
    s_add_u32 m0, s3, 41984
    s_add_u32 s0, s101, 1449984
    buffer_load_dwordx4 v210, s[40:43], s0 offen lds
    s_waitcnt vmcnt(12)
    ds_read_b64_tr_b16 a[168:169], v208 offset:49152
    ds_read_b64_tr_b16 a[172:173], v209 offset:49152
    ds_read_b64_tr_b16 a[170:171], v208 offset:50176
    ds_read_b64_tr_b16 a[174:175], v209 offset:50176
    s_waitcnt lgkmcnt(0)
    s_add_u32 m0, s3, 49152
    s_add_u32 s0, s101, 1572864
    buffer_load_dwordx4 v210, s[40:43], s0 offen lds
    s_add_u32 m0, s3, 50176
    s_add_u32 s0, s101, 1581056
    buffer_load_dwordx4 v210, s[40:43], s0 offen lds
    s_waitcnt vmcnt(12)
    ds_read_b64_tr_b16 a[176:177], v208 offset:57344
    ds_read_b64_tr_b16 a[180:181], v209 offset:57344
    ds_read_b64_tr_b16 a[178:179], v208 offset:58368
    ds_read_b64_tr_b16 a[182:183], v209 offset:58368
    s_waitcnt lgkmcnt(0)
    s_add_u32 m0, s3, 57344
    s_add_u32 s0, s101, 1703936
    buffer_load_dwordx4 v210, s[40:43], s0 offen lds
    s_add_u32 m0, s3, 58368
    s_add_u32 s0, s101, 1712128
    buffer_load_dwordx4 v210, s[40:43], s0 offen lds
    s_waitcnt vmcnt(12)
    ds_read_b64_tr_b16 a[184:185], v208 offset:2048
    ds_read_b64_tr_b16 a[188:189], v209 offset:2048
    ds_read_b64_tr_b16 a[186:187], v208 offset:3072
    ds_read_b64_tr_b16 a[190:191], v209 offset:3072
    s_waitcnt lgkmcnt(0)
    s_add_u32 m0, s3, 2048
    s_add_u32 s0, s101, 65536
    buffer_load_dwordx4 v210, s[40:43], s0 offen lds
    s_add_u32 m0, s3, 3072
    s_add_u32 s0, s101, 73728
    buffer_load_dwordx4 v210, s[40:43], s0 offen lds
    s_waitcnt vmcnt(12)
    ds_read_b64_tr_b16 a[192:193], v208 offset:10240
    ds_read_b64_tr_b16 a[196:197], v209 offset:10240
    ds_read_b64_tr_b16 a[194:195], v208 offset:11264
    ds_read_b64_tr_b16 a[198:199], v209 offset:11264
    s_waitcnt lgkmcnt(0)
    s_add_u32 m0, s3, 10240
    s_add_u32 s0, s101, 196608
    buffer_load_dwordx4 v210, s[40:43], s0 offen lds
    s_add_u32 m0, s3, 11264
    s_add_u32 s0, s101, 204800
    buffer_load_dwordx4 v210, s[40:43], s0 offen lds
    s_waitcnt vmcnt(12)
    ds_read_b64_tr_b16 a[200:201], v208 offset:18432
    ds_read_b64_tr_b16 a[204:205], v209 offset:18432
    ds_read_b64_tr_b16 a[202:203], v208 offset:19456
    ds_read_b64_tr_b16 a[206:207], v209 offset:19456
    s_waitcnt lgkmcnt(0)
    s_add_u32 m0, s3, 18432
    s_add_u32 s0, s101, 327680
    buffer_load_dwordx4 v210, s[40:43], s0 offen lds
    s_add_u32 m0, s3, 19456
    s_add_u32 s0, s101, 335872
    buffer_load_dwordx4 v210, s[40:43], s0 offen lds
    s_waitcnt vmcnt(12)
    ds_read_b64_tr_b16 a[208:209], v208 offset:32768
    ds_read_b64_tr_b16 a[212:213], v209 offset:32768
    ds_read_b64_tr_b16 a[210:211], v208 offset:33792
    ds_read_b64_tr_b16 a[214:215], v209 offset:33792
    s_waitcnt lgkmcnt(0)
    s_add_u32 m0, s3, 32768
    s_add_u32 s0, s101, 458752
    buffer_load_dwordx4 v210, s[40:43], s0 offen lds
    s_add_u32 m0, s3, 33792
    s_add_u32 s0, s101, 466944
    buffer_load_dwordx4 v210, s[40:43], s0 offen lds
    s_waitcnt vmcnt(12)
    ds_read_b64_tr_b16 a[216:217], v208 offset:40960
    ds_read_b64_tr_b16 a[220:221], v209 offset:40960
    ds_read_b64_tr_b16 a[218:219], v208 offset:41984
    ds_read_b64_tr_b16 a[222:223], v209 offset:41984
    s_and_b32 s76, s69, 1
    s_lshl_b32 s76, s76, 1
    s_add_u32 s76, s76, s75
    s_sub_u32 s76, s76, 14
    s_lshl_b32 s76, s76, 2
    s_add_u32 s76, s76, s68
    s_mul_i32 s76, s76, 56
    v_add_u32 v10, s76, v0
    v_lshrrev_b32 v144, 6, v10
    v_lshlrev_b32 v144, 17, v144
    v_and_b32 v10, 63, v10
    v_lshl_add_u32 v144, v10, 10, v144
    s_mov_b32 s76, 65536
    buffer_load_dword v145, v144, s[40:43], s76 offen offset:384
    s_waitcnt lgkmcnt(0)
    s_add_u32 m0, s3, 40960
    s_add_u32 s0, s101, 589824
    buffer_load_dwordx4 v210, s[40:43], s0 offen lds
    s_add_u32 m0, s3, 41984
    s_add_u32 s0, s101, 598016
    buffer_load_dwordx4 v210, s[40:43], s0 offen lds
    s_waitcnt vmcnt(13)
    ds_read_b64_tr_b16 a[224:225], v208 offset:49152
    ds_read_b64_tr_b16 a[228:229], v209 offset:49152
    ds_read_b64_tr_b16 a[226:227], v208 offset:50176
    ds_read_b64_tr_b16 a[230:231], v209 offset:50176
    s_waitcnt lgkmcnt(0)
    s_add_u32 m0, s3, 49152
    s_add_u32 s0, s101, 720896
    buffer_load_dwordx4 v210, s[40:43], s0 offen lds
    s_add_u32 m0, s3, 50176
    s_add_u32 s0, s101, 729088
    buffer_load_dwordx4 v210, s[40:43], s0 offen lds
    s_waitcnt vmcnt(13)
    ds_read_b64_tr_b16 a[232:233], v208 offset:57344
    ds_read_b64_tr_b16 a[236:237], v209 offset:57344
    ds_read_b64_tr_b16 a[234:235], v208 offset:58368
    ds_read_b64_tr_b16 a[238:239], v209 offset:58368
    s_waitcnt lgkmcnt(0)
    s_add_u32 m0, s3, 57344
    s_add_u32 s0, s101, 851968
    buffer_load_dwordx4 v210, s[40:43], s0 offen lds
    s_add_u32 m0, s3, 58368
    s_add_u32 s0, s101, 860160
    buffer_load_dwordx4 v210, s[40:43], s0 offen lds
    s_waitcnt vmcnt(13)
    ds_read_b64_tr_b16 a[240:241], v208 offset:2048
    ds_read_b64_tr_b16 a[244:245], v209 offset:2048
    ds_read_b64_tr_b16 a[242:243], v208 offset:3072
    ds_read_b64_tr_b16 a[246:247], v209 offset:3072
    s_waitcnt lgkmcnt(0)
    s_add_u32 m0, s3, 2048
    s_add_u32 s0, s101, 983040
    buffer_load_dwordx4 v210, s[40:43], s0 offen lds
    s_add_u32 m0, s3, 3072
    s_add_u32 s0, s101, 991232
    buffer_load_dwordx4 v210, s[40:43], s0 offen lds
    s_waitcnt vmcnt(13)
    ds_read_b64_tr_b16 a[248:249], v208 offset:10240
    ds_read_b64_tr_b16 a[252:253], v209 offset:10240
    ds_read_b64_tr_b16 a[250:251], v208 offset:11264
    ds_read_b64_tr_b16 a[254:255], v209 offset:11264
    s_waitcnt lgkmcnt(0)
    s_add_u32 m0, s3, 10240
    s_add_u32 s0, s101, 1114112
    buffer_load_dwordx4 v210, s[40:43], s0 offen lds
    s_add_u32 m0, s3, 11264
    s_add_u32 s0, s101, 1122304
    buffer_load_dwordx4 v210, s[40:43], s0 offen lds
    s_waitcnt vmcnt(13)
    ds_read_b64_tr_b16 v[240:241], v208 offset:18432
    ds_read_b64_tr_b16 v[244:245], v209 offset:18432
    ds_read_b64_tr_b16 v[242:243], v208 offset:19456
    ds_read_b64_tr_b16 v[246:247], v209 offset:19456
    s_waitcnt lgkmcnt(0)
    s_add_u32 m0, s3, 18432
    s_add_u32 s0, s101, 1245184
    buffer_load_dwordx4 v210, s[40:43], s0 offen lds
    s_add_u32 m0, s3, 19456
    s_add_u32 s0, s101, 1253376
    buffer_load_dwordx4 v210, s[40:43], s0 offen lds
    s_waitcnt vmcnt(13)
    ds_read_b64_tr_b16 v[248:249], v208 offset:32768
    ds_read_b64_tr_b16 v[252:253], v209 offset:32768
    ds_read_b64_tr_b16 v[250:251], v208 offset:33792
    ds_read_b64_tr_b16 v[254:255], v209 offset:33792
    s_waitcnt lgkmcnt(0)
    s_add_u32 m0, s3, 32768
    s_add_u32 s0, s101, 1376256
    buffer_load_dwordx4 v210, s[40:43], s0 offen lds
    s_add_u32 m0, s3, 33792
    s_add_u32 s0, s101, 1384448
    buffer_load_dwordx4 v210, s[40:43], s0 offen lds
    s_waitcnt vmcnt(12)
    ds_read_b64_tr_b16 v[16:17], v208 offset:40960
    ds_read_b64_tr_b16 v[20:21], v209 offset:40960
    ds_read_b64_tr_b16 v[18:19], v208 offset:41984
    ds_read_b64_tr_b16 v[22:23], v209 offset:41984
    s_waitcnt lgkmcnt(0)
    s_add_u32 m0, s3, 40960
    s_add_u32 s0, s101, 1507328
    buffer_load_dwordx4 v210, s[40:43], s0 offen lds
    s_add_u32 m0, s3, 41984
    s_add_u32 s0, s101, 1515520
    buffer_load_dwordx4 v210, s[40:43], s0 offen lds
    s_waitcnt vmcnt(12)
    ds_read_b64_tr_b16 v[24:25], v208 offset:49152
    ds_read_b64_tr_b16 v[28:29], v209 offset:49152
    ds_read_b64_tr_b16 v[26:27], v208 offset:50176
    ds_read_b64_tr_b16 v[30:31], v209 offset:50176
    s_waitcnt lgkmcnt(0)
    s_add_u32 m0, s3, 49152
    s_add_u32 s0, s101, 1638400
    buffer_load_dwordx4 v210, s[40:43], s0 offen lds
    s_add_u32 m0, s3, 50176
    s_add_u32 s0, s101, 1646592
    buffer_load_dwordx4 v210, s[40:43], s0 offen lds
    s_waitcnt vmcnt(12)
    ds_read_b64_tr_b16 v[32:33], v208 offset:57344
    ds_read_b64_tr_b16 v[36:37], v209 offset:57344
    ds_read_b64_tr_b16 v[34:35], v208 offset:58368
    ds_read_b64_tr_b16 v[38:39], v209 offset:58368
    s_waitcnt lgkmcnt(0)
    s_add_u32 m0, s3, 57344
    s_add_u32 s0, s101, 1769472
    buffer_load_dwordx4 v210, s[40:43], s0 offen lds
    s_add_u32 m0, s3, 58368
    s_add_u32 s0, s101, 1777664
    buffer_load_dwordx4 v210, s[40:43], s0 offen lds
    s_waitcnt vmcnt(12)
    ds_read_b64_tr_b16 v[40:41], v208 offset:2048
    ds_read_b64_tr_b16 v[44:45], v209 offset:2048
    ds_read_b64_tr_b16 v[42:43], v208 offset:3072
    ds_read_b64_tr_b16 v[46:47], v209 offset:3072
    s_waitcnt vmcnt(10)
    ds_read_b64_tr_b16 v[48:49], v208 offset:10240
    ds_read_b64_tr_b16 v[52:53], v209 offset:10240
    ds_read_b64_tr_b16 v[50:51], v208 offset:11264
    ds_read_b64_tr_b16 v[54:55], v209 offset:11264
    s_waitcnt vmcnt(8)
    ds_read_b64_tr_b16 v[56:57], v208 offset:18432
    ds_read_b64_tr_b16 v[60:61], v209 offset:18432
    ds_read_b64_tr_b16 v[58:59], v208 offset:19456
    ds_read_b64_tr_b16 v[62:63], v209 offset:19456
    s_waitcnt vmcnt(6)
    ds_read_b64_tr_b16 v[64:65], v208 offset:32768
    ds_read_b64_tr_b16 v[68:69], v209 offset:32768
    ds_read_b64_tr_b16 v[66:67], v208 offset:33792
    ds_read_b64_tr_b16 v[70:71], v209 offset:33792
    s_waitcnt vmcnt(4)
    ds_read_b64_tr_b16 v[72:73], v208 offset:40960
    ds_read_b64_tr_b16 v[76:77], v209 offset:40960
    ds_read_b64_tr_b16 v[74:75], v208 offset:41984
    ds_read_b64_tr_b16 v[78:79], v209 offset:41984
    s_waitcnt vmcnt(2)
    ds_read_b64_tr_b16 v[224:225], v208 offset:49152
    ds_read_b64_tr_b16 v[228:229], v209 offset:49152
    ds_read_b64_tr_b16 v[226:227], v208 offset:50176
    ds_read_b64_tr_b16 v[230:231], v209 offset:50176
    s_waitcnt vmcnt(0)
    ds_read_b64_tr_b16 v[232:233], v208 offset:57344
    ds_read_b64_tr_b16 v[236:237], v209 offset:57344
    ds_read_b64_tr_b16 v[234:235], v208 offset:58368
    ds_read_b64_tr_b16 v[238:239], v209 offset:58368
    s_mul_i32 s86, s71, 224
    s_add_u32 s86, s86, s68
    s_lshl_b32 s86, s86, 10
    s_add_u32 s86, s86, 4194304
    s_mul_i32 s85, s12, 114688
    s_add_u32 s11, s86, s85
    s_sub_u32 s10, s86, s85
    s_add_u32 s10, s10, 114688
    buffer_load_dword v12, v223, s[48:51], s74 offen offset:512 sc1
    s_waitcnt vmcnt(0)
    s_mov_b32 s84, 0
L_spine_142:
    v_cmp_gt_u32 vcc, 1, v12
    s_add_u32 s84, s84, 1
    s_cbranch_vccz L_donee_143
    buffer_load_dword v12, v223, s[48:51], s74 offen offset:512 sc1
    s_cmp_ge_u32 s84, 400000
    s_waitcnt vmcnt(0)
    s_cbranch_scc0 L_spine_142
L_donee_143:
    s_add_u32 s85, s10, 0
    buffer_load_dwordx4 a[0:3], v1, s[48:51], s85 offen sc1
    s_add_u32 s85, s11, 0
    buffer_load_dwordx4 a[4:7], v1, s[48:51], s85 offen sc1
    s_add_u32 s85, s10, 4096
    buffer_load_dwordx4 a[8:11], v1, s[48:51], s85 offen sc1
    s_add_u32 s85, s11, 4096
    buffer_load_dwordx4 a[12:15], v1, s[48:51], s85 offen sc1
    s_add_u32 s85, s10, 8192
    buffer_load_dwordx4 a[16:19], v1, s[48:51], s85 offen sc1
    s_add_u32 s85, s11, 8192
    buffer_load_dwordx4 a[20:23], v1, s[48:51], s85 offen sc1
    s_add_u32 s85, s10, 12288
    buffer_load_dwordx4 a[24:27], v1, s[48:51], s85 offen sc1
    s_add_u32 s85, s11, 12288
    buffer_load_dwordx4 a[28:31], v1, s[48:51], s85 offen sc1
    s_add_u32 s85, s10, 16384
    buffer_load_dwordx4 a[32:35], v1, s[48:51], s85 offen sc1
    s_add_u32 s85, s11, 16384
    buffer_load_dwordx4 a[36:39], v1, s[48:51], s85 offen sc1
    s_add_u32 s85, s10, 20480
    buffer_load_dwordx4 a[40:43], v1, s[48:51], s85 offen sc1
    s_add_u32 s85, s11, 20480
    buffer_load_dwordx4 a[44:47], v1, s[48:51], s85 offen sc1
    buffer_load_dwordx4 v[96:99], v1, s[48:51], s13 offen offset:0 sc1
    buffer_load_dwordx4 v[100:103], v1, s[48:51], s13 offen offset:1024 sc1
    buffer_load_dwordx4 v[104:107], v1, s[48:51], s13 offen offset:2048 sc1
    buffer_load_dwordx4 v[108:111], v1, s[48:51], s13 offen offset:3072 sc1
    s_waitcnt vmcnt(15)
    v_mfma_f32_32x32x16_bf16 a[96:111], a[128:131], a[0:3], 0
    s_add_u32 s85, s10, 24576
    buffer_load_dwordx4 a[48:51], v1, s[48:51], s85 offen sc1
    v_mfma_f32_32x32x16_bf16 a[112:127], a[132:135], a[0:3], 0
    s_waitcnt vmcnt(15)
    v_mfma_f32_32x32x16_bf16 a[64:79], a[128:131], a[4:7], 0
    s_add_u32 s85, s11, 24576
    buffer_load_dwordx4 a[52:55], v1, s[48:51], s85 offen sc1
    v_mfma_f32_32x32x16_bf16 a[80:95], a[132:135], a[4:7], 0
    s_waitcnt vmcnt(15)
    v_mfma_f32_32x32x16_bf16 a[96:111], a[136:139], a[8:11], a[96:111]
    s_add_u32 s85, s10, 28672
    buffer_load_dwordx4 a[56:59], v1, s[48:51], s85 offen sc1
    v_mfma_f32_32x32x16_bf16 a[112:127], a[140:143], a[8:11], a[112:127]
    s_waitcnt vmcnt(15)
    v_mfma_f32_32x32x16_bf16 a[64:79], a[136:139], a[12:15], a[64:79]
    s_add_u32 s85, s11, 28672
    buffer_load_dwordx4 a[60:63], v1, s[48:51], s85 offen sc1
    v_mfma_f32_32x32x16_bf16 a[80:95], a[140:143], a[12:15], a[80:95]
    s_waitcnt vmcnt(15)
    v_mfma_f32_32x32x16_bf16 a[96:111], a[144:147], a[16:19], a[96:111]
    s_add_u32 s85, s10, 32768
    buffer_load_dwordx4 a[0:3], v1, s[48:51], s85 offen sc1
    v_mfma_f32_32x32x16_bf16 a[112:127], a[148:151], a[16:19], a[112:127]
    s_waitcnt vmcnt(15)
    v_mfma_f32_32x32x16_bf16 a[64:79], a[144:147], a[20:23], a[64:79]
    s_add_u32 s85, s11, 32768
    buffer_load_dwordx4 a[4:7], v1, s[48:51], s85 offen sc1
    v_mfma_f32_32x32x16_bf16 a[80:95], a[148:151], a[20:23], a[80:95]
    s_waitcnt vmcnt(15)
    v_mfma_f32_32x32x16_bf16 a[96:111], a[152:155], a[24:27], a[96:111]
    s_add_u32 s85, s10, 36864
    buffer_load_dwordx4 a[8:11], v1, s[48:51], s85 offen sc1
    v_mfma_f32_32x32x16_bf16 a[112:127], a[156:159], a[24:27], a[112:127]
    s_waitcnt vmcnt(15)
    v_mfma_f32_32x32x16_bf16 a[64:79], a[152:155], a[28:31], a[64:79]
    s_add_u32 s85, s11, 36864
    buffer_load_dwordx4 a[12:15], v1, s[48:51], s85 offen sc1
    v_mfma_f32_32x32x16_bf16 a[80:95], a[156:159], a[28:31], a[80:95]
    s_waitcnt vmcnt(15)
    v_mfma_f32_32x32x16_bf16 a[96:111], a[160:163], a[32:35], a[96:111]
    s_add_u32 s85, s10, 40960
    buffer_load_dwordx4 a[16:19], v1, s[48:51], s85 offen sc1
    v_mfma_f32_32x32x16_bf16 a[112:127], a[164:167], a[32:35], a[112:127]
    s_waitcnt vmcnt(15)
    v_mfma_f32_32x32x16_bf16 a[64:79], a[160:163], a[36:39], a[64:79]
    s_add_u32 s85, s11, 40960
    buffer_load_dwordx4 a[20:23], v1, s[48:51], s85 offen sc1
    v_mfma_f32_32x32x16_bf16 a[80:95], a[164:167], a[36:39], a[80:95]
    s_waitcnt vmcnt(15)
    v_mfma_f32_32x32x16_bf16 a[96:111], a[168:171], a[40:43], a[96:111]
    s_add_u32 s85, s10, 45056
    buffer_load_dwordx4 a[24:27], v1, s[48:51], s85 offen sc1
    v_mfma_f32_32x32x16_bf16 a[112:127], a[172:175], a[40:43], a[112:127]
    s_waitcnt vmcnt(15)
    v_mfma_f32_32x32x16_bf16 a[64:79], a[168:171], a[44:47], a[64:79]
    s_add_u32 s85, s11, 45056
    buffer_load_dwordx4 a[28:31], v1, s[48:51], s85 offen sc1
    v_mfma_f32_32x32x16_bf16 a[80:95], a[172:175], a[44:47], a[80:95]
    s_waitcnt vmcnt(11)
    v_mfma_f32_32x32x16_bf16 a[96:111], a[176:179], a[48:51], a[96:111]
    s_add_u32 s85, s10, 49152
    buffer_load_dwordx4 a[32:35], v1, s[48:51], s85 offen sc1
    v_mfma_f32_32x32x16_bf16 a[112:127], a[180:183], a[48:51], a[112:127]
    s_waitcnt vmcnt(11)
    v_mfma_f32_32x32x16_bf16 a[64:79], a[176:179], a[52:55], a[64:79]
    s_add_u32 s85, s11, 49152
    buffer_load_dwordx4 a[36:39], v1, s[48:51], s85 offen sc1
    v_mfma_f32_32x32x16_bf16 a[80:95], a[180:183], a[52:55], a[80:95]
    s_waitcnt vmcnt(11)
    v_mfma_f32_32x32x16_bf16 a[96:111], a[184:187], a[56:59], a[96:111]
    s_add_u32 s85, s10, 53248
    buffer_load_dwordx4 a[40:43], v1, s[48:51], s85 offen sc1
    v_mfma_f32_32x32x16_bf16 a[112:127], a[188:191], a[56:59], a[112:127]
    s_waitcnt vmcnt(11)
    v_mfma_f32_32x32x16_bf16 a[64:79], a[184:187], a[60:63], a[64:79]
    s_add_u32 s85, s11, 53248
    buffer_load_dwordx4 a[44:47], v1, s[48:51], s85 offen sc1
    v_add_f32 v96, v96, v104
    v_add_f32 v97, v97, v105
    v_mfma_f32_32x32x16_bf16 a[80:95], a[188:191], a[60:63], a[80:95]
    v_add_f32 v98, v98, v106
    v_add_f32 v99, v99, v107
    v_add_f32 v100, v100, v108
    v_add_f32 v101, v101, v109
    v_add_f32 v102, v102, v110
    s_waitcnt vmcnt(11)
    v_mfma_f32_32x32x16_bf16 a[96:111], a[192:195], a[0:3], a[96:111]
    buffer_load_dword v12, v223, s[48:51], s74 offen offset:512 sc1
    v_add_f32 v103, v103, v111
    v_add_f32 v96, v96, v100
    v_add_f32 v97, v97, v101
    v_add_f32 v98, v98, v102
    v_mfma_f32_32x32x16_bf16 a[112:127], a[196:199], a[0:3], a[112:127]
    v_add_f32 v99, v99, v103
    v_permlane32_swap_b32 v96, v98
    s_nop 0
    v_permlane32_swap_b32 v97, v99
    s_waitcnt vmcnt(11)
    v_mfma_f32_32x32x16_bf16 a[64:79], a[192:195], a[4:7], a[64:79]
    v_add_f32 v96, v96, v98
    v_add_f32 v97, v97, v99
    s_nop 1
    v_permlane16_swap_b32 v96, v97
    v_add_f32 v96, v96, v97
    v_mul_f32 v96, 989855744, v96
    v_mfma_f32_32x32x16_bf16 a[80:95], a[196:199], a[4:7], a[80:95]
    v_mov_b32 v97, v96
    s_nop 1
    v_permlane32_swap_b32 v96, v97
    v_fma_f32 v97, -v96, v96, v97
    v_max_f32 v97, 0, v97
    s_waitcnt vmcnt(10)
    v_mfma_f32_32x32x16_bf16 a[96:111], a[200:203], a[8:11], a[96:111]
L_pad_5:
    s_cbranch_execz L_walk_3
    v_add_f32 v97, 925353388, v97
    v_rcp_f32 v120, v97
    s_xor_b32 s76, s68, 0
    s_lshl_b32 s76, s76, 12
    v_add_u32 v144, s76, v1
    s_xor_b32 s76, s68, 1
    v_mfma_f32_32x32x16_bf16 a[112:127], a[204:207], a[8:11], a[112:127]
    s_lshl_b32 s76, s76, 12
    v_add_u32 v145, s76, v1
    s_xor_b32 s76, s68, 2
    s_lshl_b32 s76, s76, 12
    v_add_u32 v146, s76, v1
    s_xor_b32 s76, s68, 3
    s_waitcnt vmcnt(9)
    v_mfma_f32_32x32x16_bf16 a[64:79], a[200:203], a[12:15], a[64:79]
    s_lshl_b32 s76, s76, 12
    v_add_u32 v147, s76, v1
    v_and_b32 v10, 31, v0
    v_lshl_add_u32 v10, v10, 10, v220
    s_lshl_b32 s77, s71, 1
    s_add_u32 s77, s77, s12
    s_lshl_b32 s77, s77, 15
    v_mfma_f32_32x32x16_bf16 a[80:95], a[204:207], a[12:15], a[80:95]
    s_lshl_b32 s76, s72, 7
    s_add_u32 s77, s77, s76
    s_and_b32 s76, s68, 1
    s_lshl_b32 s76, s76, 6
    s_add_u32 s77, s77, s76
    v_lshlrev_b32 v96, 16, v2
    s_waitcnt vmcnt(8)
    v_mfma_f32_32x32x16_bf16 a[96:111], a[208:211], a[16:19], a[96:111]
    s_waitcnt vmcnt(0)
    s_mov_b32 s84, 0
L_spinl_145:
    v_cmp_gt_u32 vcc, 2, v12
    s_add_u32 s84, s84, 1
    s_cbranch_vccz L_donel_146
    buffer_load_dword v12, v223, s[48:51], s74 offen offset:512 sc1
    s_cmp_ge_u32 s84, 400000
    s_waitcnt vmcnt(0)
    s_cbranch_scc0 L_spinl_145
L_donel_146:
    s_add_u32 s85, s10, 57344
    v_and_b32 v97, 0xffff0000, v2
    v_mfma_f32_32x32x16_bf16 a[112:127], a[212:215], a[16:19], a[112:127]
    buffer_load_dwordx4 a[48:51], v1, s[48:51], s85 offen sc1
    s_add_u32 s85, s11, 57344
    v_lshlrev_b32 v98, 16, v3
    v_and_b32 v99, 0xffff0000, v3
    v_lshlrev_b32 v100, 16, v4
    v_mfma_f32_32x32x16_bf16 a[64:79], a[208:211], a[20:23], a[64:79]
    buffer_load_dwordx4 a[52:55], v1, s[48:51], s85 offen sc1
    s_add_u32 s85, s10, 61440
    v_and_b32 v101, 0xffff0000, v4
    v_lshlrev_b32 v102, 16, v5
    v_and_b32 v103, 0xffff0000, v5
    v_lshlrev_b32 v104, 16, v6
    v_mfma_f32_32x32x16_bf16 a[80:95], a[212:215], a[20:23], a[80:95]
    buffer_load_dwordx4 a[56:59], v1, s[48:51], s85 offen sc1
    s_add_u32 s85, s11, 61440
    v_and_b32 v105, 0xffff0000, v6
    v_lshlrev_b32 v106, 16, v7
    v_and_b32 v107, 0xffff0000, v7
    v_mfma_f32_32x32x16_bf16 a[96:111], a[216:219], a[24:27], a[96:111]
    buffer_load_dwordx4 a[60:63], v1, s[48:51], s85 offen sc1
    s_add_u32 s85, s10, 65536
    v_lshlrev_b32 v108, 16, v8
    v_and_b32 v109, 0xffff0000, v8
    v_lshlrev_b32 v110, 16, v9
    v_and_b32 v111, 0xffff0000, v9
    v_mfma_f32_32x32x16_bf16 a[112:127], a[220:223], a[24:27], a[112:127]
    buffer_load_dwordx4 a[0:3], v1, s[48:51], s85 offen sc1
    s_add_u32 s85, s11, 65536
    v_mfma_f32_32x32x16_bf16 a[64:79], a[216:219], a[28:31], a[64:79]
    buffer_load_dwordx4 a[4:7], v1, s[48:51], s85 offen sc1
    s_add_u32 s85, s10, 69632
    v_mfma_f32_32x32x16_bf16 a[80:95], a[220:223], a[28:31], a[80:95]
    buffer_load_dwordx4 a[8:11], v1, s[48:51], s85 offen sc1
    s_add_u32 s85, s11, 69632
    v_mfma_f32_32x32x16_bf16 a[96:111], a[224:227], a[32:35], a[96:111]
    buffer_load_dwordx4 a[12:15], v1, s[48:51], s85 offen sc1
    s_add_u32 s85, s10, 73728
    v_mfma_f32_32x32x16_bf16 a[112:127], a[228:231], a[32:35], a[112:127]
    buffer_load_dwordx4 a[16:19], v1, s[48:51], s85 offen sc1
    v_mfma_f32_32x32x16_bf16 a[64:79], a[224:227], a[36:39], a[64:79]
    s_add_u32 s85, s11, 73728
    buffer_load_dwordx4 a[20:23], v1, s[48:51], s85 offen sc1
    v_mfma_f32_32x32x16_bf16 a[80:95], a[228:231], a[36:39], a[80:95]
    v_mfma_f32_32x32x16_bf16 a[96:111], a[232:235], a[40:43], a[96:111]
    s_add_u32 s85, s10, 77824
    buffer_load_dwordx4 a[24:27], v1, s[48:51], s85 offen sc1
    v_mfma_f32_32x32x16_bf16 a[112:127], a[236:239], a[40:43], a[112:127]
    v_mfma_f32_32x32x16_bf16 a[64:79], a[232:235], a[44:47], a[64:79]
    s_add_u32 s85, s11, 77824
    buffer_load_dwordx4 a[28:31], v1, s[48:51], s85 offen sc1
    v_mfma_f32_32x32x16_bf16 a[80:95], a[236:239], a[44:47], a[80:95]
    s_waitcnt vmcnt(11)
    v_mfma_f32_32x32x16_bf16 a[96:111], a[240:243], a[48:51], a[96:111]
    s_add_u32 s85, s10, 81920
    buffer_load_dwordx4 a[32:35], v1, s[48:51], s85 offen sc1
    v_mfma_f32_32x32x16_bf16 a[112:127], a[244:247], a[48:51], a[112:127]
    s_waitcnt vmcnt(11)
    v_mfma_f32_32x32x16_bf16 a[64:79], a[240:243], a[52:55], a[64:79]
    s_add_u32 s85, s10, 86016
    buffer_load_dwordx4 a[36:39], v1, s[48:51], s85 offen sc1
    v_mfma_f32_32x32x16_bf16 a[80:95], a[244:247], a[52:55], a[80:95]
    s_waitcnt vmcnt(11)
    v_mfma_f32_32x32x16_bf16 a[96:111], a[248:251], a[56:59], a[96:111]
    s_add_u32 s85, s10, 90112
    buffer_load_dwordx4 a[40:43], v1, s[48:51], s85 offen sc1
    v_mfma_f32_32x32x16_bf16 a[112:127], a[252:255], a[56:59], a[112:127]
    s_waitcnt vmcnt(11)
    v_mfma_f32_32x32x16_bf16 a[64:79], a[248:251], a[60:63], a[64:79]
    s_add_u32 s85, s10, 94208
    buffer_load_dwordx4 a[44:47], v1, s[48:51], s85 offen sc1
    v_mfma_f32_32x32x16_bf16 a[80:95], a[252:255], a[60:63], a[80:95]
    s_waitcnt vmcnt(11)
    v_mfma_f32_32x32x16_bf16 a[96:111], v[240:243], a[0:3], a[96:111]
    s_add_u32 s85, s10, 98304
    buffer_load_dwordx4 a[48:51], v1, s[48:51], s85 offen sc1
    v_mfma_f32_32x32x16_bf16 a[112:127], v[244:247], a[0:3], a[112:127]
    s_waitcnt vmcnt(11)
    v_mfma_f32_32x32x16_bf16 a[64:79], v[240:243], a[4:7], a[64:79]
    s_add_u32 s85, s10, 102400
    buffer_load_dwordx4 a[52:55], v1, s[48:51], s85 offen sc1
    v_mfma_f32_32x32x16_bf16 a[80:95], v[244:247], a[4:7], a[80:95]
    s_waitcnt vmcnt(11)
    v_mfma_f32_32x32x16_bf16 a[96:111], v[248:251], a[8:11], a[96:111]
    s_add_u32 s85, s10, 106496
    buffer_load_dwordx4 a[56:59], v1, s[48:51], s85 offen sc1
    v_mfma_f32_32x32x16_bf16 a[112:127], v[252:255], a[8:11], a[112:127]
    s_waitcnt vmcnt(11)
    v_mfma_f32_32x32x16_bf16 a[64:79], v[248:251], a[12:15], a[64:79]
    s_add_u32 s85, s10, 110592
    buffer_load_dwordx4 a[60:63], v1, s[48:51], s85 offen sc1
    v_mfma_f32_32x32x16_bf16 a[80:95], v[252:255], a[12:15], a[80:95]
    s_waitcnt vmcnt(11)
    v_mfma_f32_32x32x16_bf16 a[96:111], v[16:19], a[16:19], a[96:111]
    s_add_u32 s85, s11, 81920
    buffer_load_dwordx4 a[0:3], v1, s[48:51], s85 offen sc1
    v_mfma_f32_32x32x16_bf16 a[112:127], v[20:23], a[16:19], a[112:127]
    s_waitcnt vmcnt(11)
    v_mfma_f32_32x32x16_bf16 a[64:79], v[16:19], a[20:23], a[64:79]
    s_add_u32 s85, s11, 86016
    buffer_load_dwordx4 a[4:7], v1, s[48:51], s85 offen sc1
    v_mfma_f32_32x32x16_bf16 a[80:95], v[20:23], a[20:23], a[80:95]
    s_waitcnt vmcnt(11)
    v_mfma_f32_32x32x16_bf16 a[96:111], v[24:27], a[24:27], a[96:111]
    s_add_u32 s85, s11, 90112
    buffer_load_dwordx4 a[8:11], v1, s[48:51], s85 offen sc1
    v_mfma_f32_32x32x16_bf16 a[112:127], v[28:31], a[24:27], a[112:127]
    s_waitcnt vmcnt(11)
    v_mfma_f32_32x32x16_bf16 a[64:79], v[24:27], a[28:31], a[64:79]
    s_add_u32 s85, s11, 94208
    buffer_load_dwordx4 a[12:15], v1, s[48:51], s85 offen sc1
    v_mfma_f32_32x32x16_bf16 a[80:95], v[28:31], a[28:31], a[80:95]
    s_waitcnt vmcnt(11)
    v_mfma_f32_32x32x16_bf16 a[96:111], v[32:35], a[32:35], a[96:111]
    s_add_u32 s85, s11, 98304
    buffer_load_dwordx4 a[16:19], v1, s[48:51], s85 offen sc1
    v_mfma_f32_32x32x16_bf16 a[112:127], v[36:39], a[32:35], a[112:127]
    s_waitcnt vmcnt(11) lgkmcnt(15)
    v_mfma_f32_32x32x16_bf16 a[96:111], v[40:43], a[36:39], a[96:111]
    s_add_u32 s85, s11, 102400
    buffer_load_dwordx4 a[20:23], v1, s[48:51], s85 offen sc1
    v_mfma_f32_32x32x16_bf16 a[112:127], v[44:47], a[36:39], a[112:127]
    s_waitcnt vmcnt(11)
    v_mfma_f32_32x32x16_bf16 a[96:111], v[48:51], a[40:43], a[96:111]
    s_add_u32 s85, s11, 106496
    buffer_load_dwordx4 a[24:27], v1, s[48:51], s85 offen sc1
    v_mfma_f32_32x32x16_bf16 a[112:127], v[52:55], a[40:43], a[112:127]
    s_waitcnt vmcnt(11)
    v_mfma_f32_32x32x16_bf16 a[96:111], v[56:59], a[44:47], a[96:111]
    s_add_u32 s85, s11, 110592
    buffer_load_dwordx4 a[28:31], v1, s[48:51], s85 offen sc1
    v_mfma_f32_32x32x16_bf16 a[112:127], v[60:63], a[44:47], a[112:127]
    s_waitcnt vmcnt(11) lgkmcnt(12)
    v_mfma_f32_32x32x16_bf16 a[96:111], v[64:67], a[48:51], a[96:111]
    v_mfma_f32_32x32x16_bf16 a[112:127], v[68:71], a[48:51], a[112:127]
    s_waitcnt vmcnt(10) lgkmcnt(8)
    v_mfma_f32_32x32x16_bf16 a[96:111], v[72:75], a[52:55], a[96:111]
    v_mfma_f32_32x32x16_bf16 a[112:127], v[76:79], a[52:55], a[112:127]
    s_waitcnt vmcnt(9) lgkmcnt(4)
    v_mfma_f32_32x32x16_bf16 a[96:111], v[224:227], a[56:59], a[96:111]
    v_mfma_f32_32x32x16_bf16 a[112:127], v[228:231], a[56:59], a[112:127]
    s_waitcnt vmcnt(8) lgkmcnt(0)
    v_mfma_f32_32x32x16_bf16 a[96:111], v[232:235], a[60:63], a[96:111]
    s_barrier
    v_mfma_f32_32x32x16_bf16 a[112:127], v[236:239], a[60:63], a[112:127]
    s_waitcnt vmcnt(7)
    v_mfma_f32_32x32x16_bf16 a[80:95], v[36:39], a[0:3], a[80:95]
    s_waitcnt vmcnt(6)
    v_mfma_f32_32x32x16_bf16 a[80:95], v[44:47], a[4:7], a[80:95]
    s_nop 5
    ds_write_b128 v146, a[96:99] offset:18432
    ds_write_b128 v146, a[100:103] offset:19456
    s_waitcnt vmcnt(5)
    v_mfma_f32_32x32x16_bf16 a[80:95], v[52:55], a[8:11], a[80:95]
    ds_write_b128 v146, a[104:107] offset:20480
    s_waitcnt vmcnt(4)
    v_mfma_f32_32x32x16_bf16 a[80:95], v[60:63], a[12:15], a[80:95]
    ds_write_b128 v146, a[108:111] offset:21504
    s_waitcnt vmcnt(3)
    v_mfma_f32_32x32x16_bf16 a[80:95], v[68:71], a[16:19], a[80:95]
    ds_write_b128 v147, a[112:115] offset:34816
    s_waitcnt vmcnt(2)
    v_mfma_f32_32x32x16_bf16 a[80:95], v[76:79], a[20:23], a[80:95]
    ds_write_b128 v147, a[116:119] offset:35840
    s_waitcnt vmcnt(1)
    v_mfma_f32_32x32x16_bf16 a[80:95], v[228:231], a[24:27], a[80:95]
    ds_write_b128 v147, a[120:123] offset:36864
    s_waitcnt vmcnt(0)
    v_mfma_f32_32x32x16_bf16 a[80:95], v[236:239], a[28:31], a[80:95]
    ds_write_b128 v147, a[124:127] offset:37888
    v_mfma_f32_32x32x16_bf16 a[64:79], v[32:35], a[0:3], a[64:79]
    v_mfma_f32_32x32x16_bf16 a[64:79], v[40:43], a[4:7], a[64:79]
    s_waitcnt lgkmcnt(0)
    s_barrier
    ds_read_b128 v[164:167], v144 offset:18432
    ds_read_b128 v[168:171], v144 offset:19456
    ds_read_b128 v[172:175], v144 offset:20480
    ds_read_b128 v[176:179], v144 offset:21504
    v_mfma_f32_32x32x16_bf16 a[64:79], v[48:51], a[8:11], a[64:79]
    ds_read_b128 v[180:183], v144 offset:34816
    ds_read_b128 v[184:187], v144 offset:35840
    ds_read_b128 v[188:191], v144 offset:36864
    ds_read_b128 v[192:195], v144 offset:37888
    v_mfma_f32_32x32x16_bf16 a[64:79], v[56:59], a[12:15], a[64:79]
    ds_write_b128 v145, a[80:83] offset:2048
    v_mfma_f32_32x32x16_bf16 a[64:79], v[64:67], a[16:19], a[64:79]
    ds_write_b128 v145, a[84:87] offset:3072
    v_mfma_f32_32x32x16_bf16 a[64:79], v[72:75], a[20:23], a[64:79]
    ds_write_b128 v145, a[88:91] offset:4096
    v_mfma_f32_32x32x16_bf16 a[64:79], v[224:227], a[24:27], a[64:79]
    ds_write_b128 v145, a[92:95] offset:5120
    v_mfma_f32_32x32x16_bf16 a[64:79], v[232:235], a[28:31], a[64:79]
    s_waitcnt lgkmcnt(0)
    s_barrier
    ds_read_b128 v[148:151], v144 offset:2048
    ds_read_b128 v[152:155], v144 offset:3072
    ds_read_b128 v[156:159], v144 offset:4096
    ds_read_b128 v[160:163], v144 offset:5120
    v_pk_add_f32 v[164:165], v[164:165], v[180:181]
    v_pk_add_f32 v[166:167], v[166:167], v[182:183]
    v_pk_add_f32 v[168:169], v[168:169], v[184:185]
    v_pk_add_f32 v[170:171], v[170:171], v[186:187]
    v_pk_add_f32 v[172:173], v[172:173], v[188:189]
    v_pk_add_f32 v[174:175], v[174:175], v[190:191]
    v_pk_add_f32 v[176:177], v[176:177], v[192:193]
    v_pk_add_f32 v[178:179], v[178:179], v[194:195]
    v_accvgpr_read_b32 v80, a64
    v_accvgpr_read_b32 v81, a65
    v_accvgpr_read_b32 v82, a66
    v_accvgpr_read_b32 v83, a67
    v_accvgpr_read_b32 v84, a68
    v_accvgpr_read_b32 v85, a69
    v_accvgpr_read_b32 v86, a70
    v_accvgpr_read_b32 v87, a71
    v_accvgpr_read_b32 v88, a72
    v_accvgpr_read_b32 v89, a73
    v_accvgpr_read_b32 v90, a74
    v_accvgpr_read_b32 v91, a75
    v_accvgpr_read_b32 v92, a76
    v_accvgpr_read_b32 v93, a77
    v_accvgpr_read_b32 v94, a78
    v_accvgpr_read_b32 v95, a79
    v_pk_add_f32 v[80:81], v[80:81], v[164:165]
    v_pk_add_f32 v[82:83], v[82:83], v[166:167]
    v_pk_add_f32 v[84:85], v[84:85], v[168:169]
    v_pk_add_f32 v[86:87], v[86:87], v[170:171]
    v_pk_add_f32 v[88:89], v[88:89], v[172:173]
    v_pk_add_f32 v[90:91], v[90:91], v[174:175]
    v_pk_add_f32 v[92:93], v[92:93], v[176:177]
    v_pk_add_f32 v[94:95], v[94:95], v[178:179]
    s_waitcnt lgkmcnt(0)
    v_pk_add_f32 v[80:81], v[80:81], v[148:149]
    v_pk_add_f32 v[82:83], v[82:83], v[150:151]
    v_pk_add_f32 v[84:85], v[84:85], v[152:153]
    v_pk_add_f32 v[86:87], v[86:87], v[154:155]
    v_pk_fma_f32 v[80:81], v[80:81], v[120:121], v[96:97] op_sel_hi:[1,0,1]
    v_pk_fma_f32 v[82:83], v[82:83], v[120:121], v[98:99] op_sel_hi:[1,0,1]
    v_pk_fma_f32 v[84:85], v[84:85], v[120:121], v[100:101] op_sel_hi:[1,0,1]
    v_pk_fma_f32 v[86:87], v[86:87], v[120:121], v[102:103] op_sel_hi:[1,0,1]
    v_cvt_pk_bf16_f32 v112, v80, v81
    v_cvt_pk_bf16_f32 v113, v82, v83
    v_cvt_pk_bf16_f32 v114, v84, v85
    v_cvt_pk_bf16_f32 v115, v86, v87
    s_nop 0
    v_permlane32_swap_b32 v112, v114
    v_permlane32_swap_b32 v113, v115
    buffer_store_dwordx4 v[112:115], v10, s[44:47], s77 offen offset:0
    v_pk_add_f32 v[88:89], v[88:89], v[156:157]
    v_pk_add_f32 v[90:91], v[90:91], v[158:159]
    v_pk_add_f32 v[92:93], v[92:93], v[160:161]
    v_pk_add_f32 v[94:95], v[94:95], v[162:163]
    v_pk_fma_f32 v[88:89], v[88:89], v[120:121], v[104:105] op_sel_hi:[1,0,1]
    v_pk_fma_f32 v[90:91], v[90:91], v[120:121], v[106:107] op_sel_hi:[1,0,1]
    v_pk_fma_f32 v[92:93], v[92:93], v[120:121], v[108:109] op_sel_hi:[1,0,1]
    v_pk_fma_f32 v[94:95], v[94:95], v[120:121], v[110:111] op_sel_hi:[1,0,1]
    v_cvt_pk_bf16_f32 v116, v88, v89
    v_cvt_pk_bf16_f32 v117, v90, v91
    v_cvt_pk_bf16_f32 v118, v92, v93
    v_cvt_pk_bf16_f32 v119, v94, v95
    s_nop 0
    v_permlane32_swap_b32 v116, v118
    v_permlane32_swap_b32 v117, v119
    buffer_store_dwordx4 v[116:119], v10, s[44:47], s77 offen offset:32
L_exit:
    s_endpgm
L_gspin_9:
    s_mov_b32 s84, 0
    v_mov_b32 v10, s9
    v_lshrrev_b32 v95, 4, v11
    v_lshlrev_b32 v95, 2, v95
    s_mov_b64 exec, 1
    buffer_store_dword v10, v95, s[48:51], s74 offen offset:896 sc1
    s_mov_b64 exec, -1
L_loop_150:
    buffer_load_dword v92, v88, s[48:51], s74 offen offset:768 sc1
    buffer_load_dword v10, v88, s[48:51], s74 offen offset:896 sc1
    s_add_u32 s84, s84, 1
    s_cmp_ge_u32 s84, 400000
    s_cbranch_scc1 L_gdone_151
    s_waitcnt vmcnt(0)
    v_or_b32 v92, v92, v10
    v_cmp_eq_u32 vcc, 0, v92
    s_nop 0
    s_cbranch_vccnz L_loop_150
L_gdone_151:
    s_waitcnt vmcnt(0)
    v_cmp_ne_u32 vcc, s9, v92
    s_nop 0
    s_cbranch_vccz L_gback_10
    s_mov_b32 s54, 0
    s_mov_b32 s58, 12582912
    s_branch L_gback_10
L_code_end:
    s_endpgm
.section .rodata,"a"
.p2align 6
.amdhsa_kernel sequential_preLN__sliding_local_dilated__glu_gated_bilinear__prompt_kernel
  .amdhsa_next_free_vgpr 512
  .amdhsa_next_free_sgpr 102
  .amdhsa_accum_offset 256
  .amdhsa_group_segment_fixed_size 0
  .amdhsa_kernarg_size 80
  .amdhsa_user_sgpr_count 2
  .amdhsa_user_sgpr_kernarg_segment_ptr 1
  .amdhsa_system_sgpr_workgroup_id_x 1
.end_amdhsa_kernel
```
